```python
import torch

def _softmax(x, axis=-1):
    return torch.softmax(x, dim=axis)
def _gelu(x):
    return torch.nn.functional.gelu(x, approximate="tanh")
def _silu(x):
    return torch.nn.functional.silu(x)
def _sigmoid(x):
    return torch.sigmoid(x)
def _layernorm(x, axis=-1, eps=1e-5):
    m = x.mean(dim=axis, keepdim=True)
    v = x.var(dim=axis, keepdim=True, unbiased=False)
    return (x - m) / torch.sqrt(v + eps)
def _scatter_add(tgt, idx, src, axis=0):
    return tgt.clone().index_add_(axis, idx, src)
def _segment_sum(src, seg, n):
    out = torch.zeros((n,) + src.shape[1:], dtype=src.dtype)
    return out.index_add_(0, seg, src)
def _pad(x, pw):
    flat = tuple(v for pair in reversed(pw) for v in pair)
    return torch.nn.functional.pad(x, flat)

kernel_name = 'concat_heads__sliding_local_dilated__spectral_fnet__prompt'

def setup_inputs():

    _w = (lambda a: (lambda t: t.to(torch.bfloat16) if t.is_floating_point() else t)(torch.as_tensor(a)))
    def _A_setup():
        B, S, D = 1, 2048, 512
        return {
            "x": _w((lambda *s: torch.randn(*s, dtype=torch.bfloat16) * 0.2)(B, S, D)),
            "wqkv": _w((lambda *s: torch.randn(*s, dtype=torch.bfloat16) * 0.8)(D, 3 * D)),
            "wo": _w((lambda *s: torch.randn(*s, dtype=torch.bfloat16) * 0.2)(D, D)),
        }
    _A_in = _A_setup()

    def _B_setup():
        B, S, D = 1, 2048, 512
        ns = torch.arange(S)[:, None] * torch.arange(S)[None, :]
        nd = torch.arange(D)[:, None] * torch.arange(D)[None, :]
        Ws_re = torch.cos(-2.0 * torch.pi * ns / S).to(float)
        Ws_im = torch.sin(-2.0 * torch.pi * ns / S).to(float)
        Wd_re = torch.cos(-2.0 * torch.pi * nd / D).to(float)
        Wd_im = torch.sin(-2.0 * torch.pi * nd / D).to(float)
        return {
            "x": _w((lambda *s: torch.randn(*s, dtype=torch.bfloat16) * 0.05)(B, S, D)),
            "dft_seq_re": _w(Ws_re),
            "dft_seq_im": _w(Ws_im),
            "dft_hid_re": _w(Wd_re),
            "dft_hid_im": _w(Wd_im),
        }
    _B_in = _B_setup()

    return {
        "A_x": _A_in["x"],
        "A_wqkv": _A_in["wqkv"],
        "A_wo": _A_in["wo"],
        "B_x": _B_in["x"],
        "B_dft_seq_re": _B_in["dft_seq_re"],
        "B_dft_seq_im": _B_in["dft_seq_im"],
        "B_dft_hid_re": _B_in["dft_hid_re"],
        "B_dft_hid_im": _B_in["dft_hid_im"],
    }

def reference(A_x, A_wqkv, A_wo, B_x, B_dft_seq_re, B_dft_seq_im, B_dft_hid_re, B_dft_hid_im):
    def _A_ref(x, wqkv, wo):
        B, S, D = x.shape
        H = 32; Dh = D // H
        W, dil = 8, 2
        qkv = (lambda x, *d: x.permute(*d))((x @ wqkv).reshape(B, S, 3, H, Dh), 2, 0, 3, 1, 4)
        q, k, v = qkv[0], qkv[1], qkv[2]
        scale = Dh ** -0.5
        pos = torch.arange(S)
        off = torch.arange(W) * dil
        idx = pos[:, None] - off[None, :]
        mask = idx >= 0
        idx_c = torch.where(mask, idx, 0).reshape(-1)
        kg = k[:, :, idx_c, :].reshape(B, H, S, W, Dh)
        vg = v[:, :, idx_c, :].reshape(B, H, S, W, Dh)
        logits = torch.einsum("bhsd,bhswd->bhsw", q, kg) * scale
        logits = torch.where(mask[None, None, :, :], logits, -1e9)
        attn = _softmax(logits, axis=-1)
        o = torch.einsum("bhsw,bhswd->bhsd", attn, vg)
        return (lambda x, *d: x.permute(*d))(o, 0, 2, 1, 3).reshape(B, S, D) @ wo

    def _B_ref(x, dft_seq_re, dft_seq_im, dft_hid_re, dft_hid_im):
        a = torch.einsum("bsd,ed->bse", x, dft_hid_re)
        b = torch.einsum("bsd,ed->bse", x, dft_hid_im)
        y = torch.einsum("ts,bse->bte", dft_seq_re, a) - torch.einsum("ts,bse->bte", dft_seq_im, b)
        return y

    a = _A_ref(A_x, A_wqkv, A_wo)
    b = _B_ref(B_x, B_dft_seq_re, B_dft_seq_im, B_dft_hid_re, B_dft_hid_im)
    return torch.concatenate([a, b], axis=-1)
```

```asm
; @launch grid=(256,1,1) block=(512,1,1) lds=163840
.amdgcn_target "amdgcn-amd-amdhsa--gfx950"
.text
.globl concat_heads__sliding_local_dilated__spectral_fnet__prompt_kernel
.p2align 12
.p2align 8
.type concat_heads__sliding_local_dilated__spectral_fnet__prompt_kernel,@function
concat_heads__sliding_local_dilated__spectral_fnet__prompt_kernel:
    s_load_dwordx8 s[36:43], s[0:1], 0
    s_load_dwordx4 s[52:55], s[0:1], 64
    s_load_dwordx2 s[56:57], s[0:1], 80
    s_cmp_ge_u32 s2, 256
    s_cbranch_scc1 K_END
    s_getpc_b64 s[8:9]
K_PC:
    s_lshr_b32 s5, s2, 3
    s_lshl_b32 s5, s5, 10
    s_cmp_lt_u32 s5, K_PAD-concat_heads__sliding_local_dilated__spectral_fnet__prompt_kernel
    s_cselect_b32 s10, 64, 0
    s_sub_u32 s8, s8, K_PC-concat_heads__sliding_local_dilated__spectral_fnet__prompt_kernel
    s_subb_u32 s9, s9, 0
    v_lshl_add_u32 v1, v0, 4, s5
    v_mov_b32 v3, s9
    v_add_co_u32 v2, vcc, s8, v1
    s_nop 1
    v_addc_co_u32 v3, vcc, 0, v3, vcc
    v_cmp_gt_u32 vcc, s10, v0
    s_and_saveexec_b64 s[6:7], vcc
    s_cbranch_execz K_NOPF
    global_load_dwordx4 v[248:251], v[2:3], off
K_NOPF:
    s_mov_b64 exec, s[6:7]
    v_lshrrev_b32 v1, 6, v0
    v_and_b32 v2, 63, v0
    v_readfirstlane_b32 s3, v1
    s_and_b32 s4, s2, 7
    s_lshr_b32 s5, s2, 3
    v_and_b32 v3, 15, v2
    v_lshrrev_b32 v4, 4, v2
    v_lshrrev_b32 v5, 3, v2
    v_and_b32 v6, 7, v2
    s_cmp_ge_u32 s5, 24
    s_cbranch_scc1 K_B
    s_mul_i32 s7, s4, 3
    s_lshr_b32 s28, s5, 3
    s_add_u32 s59, s7, s28
    s_and_b32 s29, s5, 7
    s_and_b32 s30, s59, 1
    s_lshr_b32 s31, s59, 1
    s_mul_i32 s32, s31, 88
    s_xor_b32 s3, s3, 4
    s_getreg_b32 s96, hwreg(HW_REG_XCC_ID, 0, 4)
    s_add_u32 s96, s96, 0x100
    s_cmp_ge_u32 s3, 4
    s_cbranch_scc0 K_A_CONS
    s_mul_i32 s97, s28, 3
    s_mov_b32 s63, 0
    s_mul_i32 s62, s4, 1
    s_add_u32 s63, s63, s62
    s_add_u32 s63, s63, s29
    s_sub_u32 s33, s3, 4
    s_mul_i32 s6, s33, 24
    v_add_u32 v7, s6, v5
    v_add_u32 v7, 0, v7
    v_lshrrev_b32 v8, 1, v7
    v_and_b32 v8, 7, v8
    v_xor_b32 v8, v8, v6
    v_lshlrev_b32 v8, 4, v8
    v_add_u32 v7, s32, v7
    v_lshlrev_b32 v7, 1, v7
    v_add_u32 v7, s30, v7
    v_lshl_add_u32 v10, v7, 10, v8
    v_add_u32 v7, s6, v5
    v_add_u32 v7, 8, v7
    v_lshrrev_b32 v8, 1, v7
    v_and_b32 v8, 7, v8
    v_xor_b32 v8, v8, v6
    v_lshlrev_b32 v8, 4, v8
    v_add_u32 v7, s32, v7
    v_lshlrev_b32 v7, 1, v7
    v_add_u32 v7, s30, v7
    v_lshl_add_u32 v11, v7, 10, v8
    v_add_u32 v7, s6, v5
    v_add_u32 v7, 16, v7
    v_lshrrev_b32 v8, 1, v7
    v_and_b32 v8, 7, v8
    v_xor_b32 v8, v8, v6
    v_lshlrev_b32 v8, 4, v8
    v_add_u32 v7, s32, v7
    v_lshlrev_b32 v7, 1, v7
    v_add_u32 v7, s30, v7
    v_lshl_add_u32 v12, v7, 10, v8
    s_lshl_b32 s6, s33, 4
    s_lshl_b32 s7, s29, 7
    s_movk_i32 s28, 3072
    v_add_u32 v7, s6, v5
    v_add_u32 v7, 0, v7
    v_mul_lo_u32 v7, v7, s28
    v_add_u32 v7, s7, v7
    v_and_b32 v8, 1, v4
    v_or_b32 v8, 0, v8
    v_lshlrev_b32 v8, 1, v8
    v_xor_b32 v8, v8, v6
    v_lshl_add_u32 v13, v8, 4, v7
    v_add_u32 v7, s6, v5
    v_add_u32 v7, 8, v7
    v_mul_lo_u32 v7, v7, s28
    v_add_u32 v7, s7, v7
    v_and_b32 v8, 1, v4
    v_or_b32 v8, 2, v8
    v_lshlrev_b32 v8, 1, v8
    v_xor_b32 v8, v8, v6
    v_lshl_add_u32 v14, v8, 4, v7
    s_mul_i32 s34, s33, 3072
    s_mul_i32 s35, s33, 6144
    s_add_u32 s35, s35, 12288
    s_waitcnt lgkmcnt(0)
    s_mov_b32 s8, s36
    s_mov_b32 s9, s37
    s_mov_b32 s10, 0x200000
    s_mov_b32 s11, 0x20000
    s_mov_b32 s12, s38
    s_mov_b32 s13, s39
    s_mov_b32 s14, 0x180000
    s_mov_b32 s15, 0x20000
    s_add_u32 s62, s63, 0
    s_and_b32 s62, s62, 7
    s_lshl_b32 s6, s62, 7
    s_add_u32 m0, s34, 0
    s_nop 0
    buffer_load_dwordx4 v10, s[8:11], s6 offen lds
    s_add_u32 m0, s34, 1024
    s_nop 0
    buffer_load_dwordx4 v11, s[8:11], s6 offen lds
    s_add_u32 m0, s34, 2048
    s_nop 0
    buffer_load_dwordx4 v12, s[8:11], s6 offen lds
    s_mul_i32 s7, s62, 196608
    s_add_u32 m0, s35, 0
    s_nop 0
    buffer_load_dwordx4 v13, s[12:15], s7 offen offset:0 lds
    buffer_load_dwordx4 v13, s[12:15], s7 offen offset:1024 lds
    buffer_load_dwordx4 v13, s[12:15], s7 offen offset:2048 lds
    s_add_u32 m0, s35, 3072
    s_nop 0
    buffer_load_dwordx4 v14, s[12:15], s7 offen offset:0 lds
    buffer_load_dwordx4 v14, s[12:15], s7 offen offset:1024 lds
    buffer_load_dwordx4 v14, s[12:15], s7 offen offset:2048 lds
    s_add_u32 s62, s63, 1
    s_and_b32 s62, s62, 7
    s_lshl_b32 s6, s62, 7
    s_add_u32 m0, s34, 36864
    s_nop 0
    buffer_load_dwordx4 v10, s[8:11], s6 offen lds
    s_add_u32 m0, s34, 37888
    s_nop 0
    buffer_load_dwordx4 v11, s[8:11], s6 offen lds
    s_add_u32 m0, s34, 38912
    s_nop 0
    buffer_load_dwordx4 v12, s[8:11], s6 offen lds
    s_mov_b32 s16, s40
    s_mov_b32 s17, s41
    s_mov_b32 s18, 0x80000
    s_mov_b32 s19, 0x20000
    s_add_u32 s20, s56, 0x0
    s_addc_u32 s21, s57, 0
    s_mov_b32 s22, 0x240000
    s_mov_b32 s23, 0x20000
    s_lshl_b32 s60, s33, 3
    v_add_u32 v7, s60, v5
    s_and_b32 s60, s33, 1
    s_lshl_b32 s60, s60, 1
    s_xor_b32 s61, s29, 1
    s_lshl_b32 s61, s61, 7
    v_and_b32 v8, 1, v4
    v_or_b32 v8, s60, v8
    v_lshlrev_b32 v8, 1, v8
    v_xor_b32 v8, v8, v6
    v_lshlrev_b32 v8, 4, v8
    v_lshl_add_u32 v15, v7, 10, v8
    v_add_u32 v15, s61, v15
    s_lshl_b32 s58, s33, 10
    s_mul_i32 s60, s33, 24
    v_add_u32 v7, s60, v2
    v_lshrrev_b32 v8, 4, v7
    v_lshlrev_b32 v8, 14, v8
    v_and_b32 v7, 15, v7
    v_lshl_add_u32 v7, v7, 7, v8
    v_mov_b32 v8, 0x80000000
    v_cmp_le_u32 vcc, 24, v2
    s_mul_i32 s60, s59, 98304
    s_lshl_b32 s61, s29, 11
    s_add_u32 s98, s60, s61
    v_cndmask_b32 v16, v7, v8, vcc
    v_mov_b32 v17, 147456
    v_mov_b32 v18, 0
    v_mov_b32_e64 v19, 0
    ds_write_b64 v17, v[18:19]
    ds_write_b64 v17, v[18:19] offset:8
    ds_write_b64 v17, v[18:19] offset:16
    ds_write_b64 v17, v[18:19] offset:24
    s_waitcnt lgkmcnt(0)
    v_mov_b32 v18, 1
    s_mov_b32 s44, s52
    s_mov_b32 s45, s53
    s_mov_b32 s46, 0x400000
    s_mov_b32 s47, 0x20000
    v_bfe_u32 v7, v2, 2, 2
    v_lshrrev_b32 v8, 1, v7
    v_and_b32 v9, 1, v4
    v_lshl_or_b32 v8, v9, 1, v8
    v_lshlrev_b32 v9, 10, v4
    v_lshl_add_u32 v9, v7, 7, v9
    v_and_b32 v7, 3, v2
    v_lshl_add_u32 v9, v7, 3, v9
    v_xor_b32 v7, 0, v8
    v_lshl_add_u32 v24, v7, 5, v9
    v_xor_b32 v7, 1, v8
    v_lshl_add_u32 v25, v7, 5, v9
    v_xor_b32 v7, 2, v8
    v_lshl_add_u32 v26, v7, 5, v9
    v_xor_b32 v7, 3, v8
    v_lshl_add_u32 v27, v7, 5, v9
    v_lshlrev_b32_e64 v33, 4, v2
    s_mul_i32 s60, s33, 4608
    s_add_u32 s60, s60, 73728
    v_mul_u32_u24 v30, 144, v3
    v_lshl_add_u32 v30, v4, 3, v30
    v_add_u32 v30, s60, v30
    v_mul_u32_u24 v31, 144, v5
    v_lshl_add_u32 v31, v6, 4, v31
    v_add_u32 v31, s60, v31
    v_lshlrev_b32 v32, 12, v5
    v_lshl_add_u32 v32, v6, 4, v32
    s_lshl_b32 s60, s32, 12
    s_lshl_b32 s61, s30, 11
    s_add_u32 s60, s60, s61
    s_xor_b32 s61, s29, 1
    s_lshl_b32 s61, s61, 7
    s_add_u32 s42, s60, s61
    s_lshl_b32 s60, s33, 16
    s_add_u32 s48, s42, s60
    s_add_u32 s49, s48, 0x8000
    s_lshr_b32 s61, s33, 1
    s_add_u32 s61, s61, 4
    s_lshl_b32 s60, s61, 16
    s_add_u32 s50, s42, s60
    s_add_u32 s51, s50, 0x8000
    s_mul_i32 s42, s59, 98304
    s_lshl_b32 s60, s33, 14
    s_add_u32 s43, s42, s60
    s_lshl_b32 s60, s61, 14
    s_add_u32 s42, s42, s60
    s_lshr_b32 s60, s33, 1
    s_lshl_b32 s61, s60, 12
    s_add_u32 s61, s61, 92160
    v_add_u32 v28, s61, v33
    s_lshl_b32 s60, s60, 2
    v_add_u32 v29, s60, v17
    s_cmp_lg_u32 s31, 0
    s_cselect_b32 s60, 1, 0
    s_cmp_eq_u32 s33, 0
    s_cselect_b32 s60, s60, 0
    s_cmp_lg_u32 s60, 0
    s_cselect_b32 s48, 0x40000000, s48
    s_waitcnt vmcnt(3)
    s_barrier
    s_mul_i32 s7, s62, 196608
    s_add_u32 m0, s35, 36864
    s_nop 0
    buffer_load_dwordx4 v13, s[12:15], s7 offen offset:0 lds
    buffer_load_dwordx4 v13, s[12:15], s7 offen offset:1024 lds
    buffer_load_dwordx4 v13, s[12:15], s7 offen offset:2048 lds
    s_add_u32 m0, s35, 39936
    s_nop 0
    buffer_load_dwordx4 v14, s[12:15], s7 offen offset:0 lds
    buffer_load_dwordx4 v14, s[12:15], s7 offen offset:1024 lds
    buffer_load_dwordx4 v14, s[12:15], s7 offen offset:2048 lds
    s_add_u32 s62, s63, 2
    s_and_b32 s62, s62, 7
    s_lshl_b32 s6, s62, 7
    s_add_u32 m0, s34, 73728
    s_nop 0
    buffer_load_dwordx4 v10, s[8:11], s6 offen lds
    s_add_u32 m0, s34, 74752
    s_nop 0
    buffer_load_dwordx4 v11, s[8:11], s6 offen lds
    s_add_u32 m0, s34, 75776
    s_nop 0
    buffer_load_dwordx4 v12, s[8:11], s6 offen lds
    s_mul_i32 s7, s62, 196608
    s_add_u32 m0, s35, 73728
    s_nop 0
    buffer_load_dwordx4 v13, s[12:15], s7 offen offset:0 lds
    buffer_load_dwordx4 v13, s[12:15], s7 offen offset:1024 lds
    buffer_load_dwordx4 v13, s[12:15], s7 offen offset:2048 lds
    s_add_u32 m0, s35, 76800
    s_nop 0
    buffer_load_dwordx4 v14, s[12:15], s7 offen offset:0 lds
    buffer_load_dwordx4 v14, s[12:15], s7 offen offset:1024 lds
    buffer_load_dwordx4 v14, s[12:15], s7 offen offset:2048 lds
    s_add_u32 s62, s63, 3
    s_and_b32 s62, s62, 7
    s_lshl_b32 s6, s62, 7
    s_add_u32 m0, s34, 110592
    s_nop 0
    buffer_load_dwordx4 v10, s[8:11], s6 offen lds
    s_waitcnt vmcnt(10)
    s_barrier
    s_add_u32 m0, s34, 111616
    s_nop 0
    buffer_load_dwordx4 v11, s[8:11], s6 offen lds
    s_add_u32 m0, s34, 112640
    s_nop 0
    buffer_load_dwordx4 v12, s[8:11], s6 offen lds
    s_mul_i32 s7, s62, 196608
    s_add_u32 m0, s35, 110592
    s_nop 0
    buffer_load_dwordx4 v13, s[12:15], s7 offen offset:0 lds
    buffer_load_dwordx4 v13, s[12:15], s7 offen offset:1024 lds
    buffer_load_dwordx4 v13, s[12:15], s7 offen offset:2048 lds
    s_add_u32 m0, s35, 113664
    s_nop 0
    buffer_load_dwordx4 v14, s[12:15], s7 offen offset:0 lds
    buffer_load_dwordx4 v14, s[12:15], s7 offen offset:1024 lds
    buffer_load_dwordx4 v14, s[12:15], s7 offen offset:2048 lds
    s_add_u32 s62, s63, 4
    s_and_b32 s62, s62, 7
    s_lshl_b32 s6, s62, 7
    s_add_u32 m0, s34, 0
    s_nop 0
    buffer_load_dwordx4 v10, s[8:11], s6 offen lds
    s_waitcnt vmcnt(10)
    s_barrier
    s_add_u32 m0, s34, 1024
    s_nop 0
    buffer_load_dwordx4 v11, s[8:11], s6 offen lds
    s_add_u32 m0, s34, 2048
    s_nop 0
    buffer_load_dwordx4 v12, s[8:11], s6 offen lds
    s_mul_i32 s7, s62, 196608
    s_add_u32 m0, s35, 0
    s_nop 0
    buffer_load_dwordx4 v13, s[12:15], s7 offen offset:0 lds
    buffer_load_dwordx4 v13, s[12:15], s7 offen offset:1024 lds
    buffer_load_dwordx4 v13, s[12:15], s7 offen offset:2048 lds
    s_add_u32 m0, s35, 3072
    s_nop 0
    buffer_load_dwordx4 v14, s[12:15], s7 offen offset:0 lds
    buffer_load_dwordx4 v14, s[12:15], s7 offen offset:1024 lds
    buffer_load_dwordx4 v14, s[12:15], s7 offen offset:2048 lds
    s_add_u32 s62, s63, 5
    s_and_b32 s62, s62, 7
    s_lshl_b32 s6, s62, 7
    s_add_u32 m0, s34, 36864
    s_nop 0
    buffer_load_dwordx4 v10, s[8:11], s6 offen lds
    s_waitcnt vmcnt(10)
    s_barrier
    s_add_u32 m0, s34, 37888
    s_nop 0
    buffer_load_dwordx4 v11, s[8:11], s6 offen lds
    s_add_u32 m0, s34, 38912
    s_nop 0
    buffer_load_dwordx4 v12, s[8:11], s6 offen lds
    s_mul_i32 s7, s62, 196608
    s_add_u32 m0, s35, 36864
    s_nop 0
    buffer_load_dwordx4 v13, s[12:15], s7 offen offset:0 lds
    buffer_load_dwordx4 v13, s[12:15], s7 offen offset:1024 lds
    buffer_load_dwordx4 v13, s[12:15], s7 offen offset:2048 lds
    s_add_u32 m0, s35, 39936
    s_nop 0
    buffer_load_dwordx4 v14, s[12:15], s7 offen offset:0 lds
    buffer_load_dwordx4 v14, s[12:15], s7 offen offset:1024 lds
    buffer_load_dwordx4 v14, s[12:15], s7 offen offset:2048 lds
    s_add_u32 s62, s63, 6
    s_and_b32 s62, s62, 7
    s_lshl_b32 s6, s62, 7
    s_add_u32 m0, s34, 73728
    s_nop 0
    buffer_load_dwordx4 v10, s[8:11], s6 offen lds
    s_waitcnt vmcnt(10)
    s_barrier
    s_add_u32 m0, s34, 74752
    s_nop 0
    buffer_load_dwordx4 v11, s[8:11], s6 offen lds
    s_add_u32 m0, s34, 75776
    s_nop 0
    buffer_load_dwordx4 v12, s[8:11], s6 offen lds
    s_mul_i32 s7, s62, 196608
    s_add_u32 m0, s35, 73728
    s_nop 0
    buffer_load_dwordx4 v13, s[12:15], s7 offen offset:0 lds
    buffer_load_dwordx4 v13, s[12:15], s7 offen offset:1024 lds
    buffer_load_dwordx4 v13, s[12:15], s7 offen offset:2048 lds
    s_add_u32 m0, s35, 76800
    s_nop 0
    buffer_load_dwordx4 v14, s[12:15], s7 offen offset:0 lds
    buffer_load_dwordx4 v14, s[12:15], s7 offen offset:1024 lds
    buffer_load_dwordx4 v14, s[12:15], s7 offen offset:2048 lds
    s_add_u32 s62, s63, 7
    s_and_b32 s62, s62, 7
    s_lshl_b32 s6, s62, 7
    s_add_u32 m0, s34, 110592
    s_nop 0
    buffer_load_dwordx4 v10, s[8:11], s6 offen lds
    s_waitcnt vmcnt(10)
    s_barrier
    s_add_u32 m0, s34, 111616
    s_nop 0
    buffer_load_dwordx4 v11, s[8:11], s6 offen lds
    s_add_u32 m0, s34, 112640
    s_nop 0
    buffer_load_dwordx4 v12, s[8:11], s6 offen lds
    s_mul_i32 s7, s62, 196608
    s_add_u32 m0, s35, 110592
    s_nop 0
    buffer_load_dwordx4 v13, s[12:15], s7 offen offset:0 lds
    buffer_load_dwordx4 v13, s[12:15], s7 offen offset:1024 lds
    buffer_load_dwordx4 v13, s[12:15], s7 offen offset:2048 lds
    s_add_u32 m0, s35, 113664
    s_nop 0
    buffer_load_dwordx4 v14, s[12:15], s7 offen offset:0 lds
    buffer_load_dwordx4 v14, s[12:15], s7 offen offset:1024 lds
    buffer_load_dwordx4 v14, s[12:15], s7 offen offset:2048 lds
    s_add_u32 s88, s56, 0x500000
    s_addc_u32 s89, s57, 0
    s_mov_b32 s90, 0x10000
    s_mov_b32 s91, 0x20000
    s_mov_b32 s24, s54
    s_mov_b32 s25, s55
    s_mov_b32 s26, 0x100
    s_mov_b32 s27, 0x20000
    v_lshlrev_b32 v20, 2, v6
    v_lshlrev_b32 v21, 7, v6
    s_lshl_b32 s100, s59, 10
    s_lshr_b32 s97, s5, 3
    s_mul_i32 s97, s97, 5
    s_mov_b64 exec, 0xff
    buffer_load_dword v22, v20, s[24:27], 0 offen sc1
    s_mov_b64 exec, -1
    s_waitcnt vmcnt(10)
    s_barrier
    s_mov_b64 exec, 0xff
    buffer_load_dword v251, v21, s[88:91], s100 offen sc1
    s_mov_b64 exec, -1
    s_add_u32 s62, s97, 0
    s_and_b32 s62, s62, 15
    s_lshl_b32 s6, s62, 12
    s_add_u32 m0, s58, s6
    s_lshl_b32 s6, s62, 15
    buffer_load_dwordx4 v15, s[16:19], s6 offen lds
    s_add_u32 s62, s97, 1
    s_and_b32 s62, s62, 15
    s_lshl_b32 s6, s62, 12
    s_add_u32 m0, s58, s6
    s_lshl_b32 s6, s62, 15
    buffer_load_dwordx4 v15, s[16:19], s6 offen lds
    s_add_u32 s62, s97, 2
    s_and_b32 s62, s62, 15
    s_lshl_b32 s6, s62, 12
    s_add_u32 m0, s58, s6
    s_lshl_b32 s6, s62, 15
    buffer_load_dwordx4 v15, s[16:19], s6 offen lds
    s_add_u32 s62, s97, 3
    s_and_b32 s62, s62, 15
    s_lshl_b32 s6, s62, 12
    s_add_u32 m0, s58, s6
    s_lshl_b32 s6, s62, 15
    buffer_load_dwordx4 v15, s[16:19], s6 offen lds
    s_waitcnt vmcnt(6)
    s_barrier
    s_waitcnt vmcnt(5)
    s_mov_b64 exec, 0xff
    v_cmp_ne_u32 vcc, 1, v22
    s_cmp_eq_u64 vcc, 0
    s_cbranch_scc1 K_A_RDY_X
    s_mov_b32 s28, 0
K_A_RDY:
    buffer_load_dword v9, v20, s[24:27], 0 offen sc1
    s_add_u32 s28, s28, 1
    s_cmp_ge_u32 s28, 400000
    s_cbranch_scc1 K_A_RDY_X
    s_waitcnt vmcnt(0)
    v_cmp_ne_u32 vcc, 1, v9
    s_cmp_lg_u64 vcc, 0
    s_cbranch_scc1 K_A_RDY
K_A_RDY_X:
    ds_write_b32 v17, v18 offset:24
    s_mov_b64 exec, -1
    s_add_u32 s62, s97, 4
    s_and_b32 s62, s62, 15
    s_lshl_b32 s6, s62, 12
    s_add_u32 m0, s58, s6
    s_lshl_b32 s6, s62, 15
    buffer_load_dwordx4 v15, s[16:19], s6 offen lds
    s_add_u32 s62, s97, 5
    s_and_b32 s62, s62, 15
    s_lshl_b32 s6, s62, 12
    s_add_u32 m0, s58, s6
    s_lshl_b32 s6, s62, 15
    buffer_load_dwordx4 v15, s[16:19], s6 offen lds
    s_add_u32 s62, s97, 6
    s_and_b32 s62, s62, 15
    s_lshl_b32 s6, s62, 12
    s_add_u32 m0, s58, s6
    s_lshl_b32 s6, s62, 15
    buffer_load_dwordx4 v15, s[16:19], s6 offen lds
    s_add_u32 s62, s97, 7
    s_and_b32 s62, s62, 15
    s_lshl_b32 s6, s62, 12
    s_add_u32 m0, s58, s6
    s_lshl_b32 s6, s62, 15
    buffer_load_dwordx4 v15, s[16:19], s6 offen lds
    s_add_u32 s62, s97, 8
    s_and_b32 s62, s62, 15
    s_lshl_b32 s6, s62, 12
    s_add_u32 m0, s58, s6
    s_lshl_b32 s6, s62, 15
    buffer_load_dwordx4 v15, s[16:19], s6 offen lds
    s_add_u32 s62, s97, 9
    s_and_b32 s62, s62, 15
    s_lshl_b32 s6, s62, 12
    s_add_u32 m0, s58, s6
    s_lshl_b32 s6, s62, 15
    buffer_load_dwordx4 v15, s[16:19], s6 offen lds
    s_add_u32 s62, s97, 10
    s_and_b32 s62, s62, 15
    s_lshl_b32 s6, s62, 12
    s_add_u32 m0, s58, s6
    s_lshl_b32 s6, s62, 15
    buffer_load_dwordx4 v15, s[16:19], s6 offen lds
    s_add_u32 s62, s97, 11
    s_and_b32 s62, s62, 15
    s_lshl_b32 s6, s62, 12
    s_add_u32 m0, s58, s6
    s_lshl_b32 s6, s62, 15
    buffer_load_dwordx4 v15, s[16:19], s6 offen lds
    s_add_u32 s62, s97, 12
    s_and_b32 s62, s62, 15
    s_lshl_b32 s6, s62, 12
    s_add_u32 m0, s58, s6
    s_lshl_b32 s6, s62, 15
    buffer_load_dwordx4 v15, s[16:19], s6 offen lds
    s_add_u32 s62, s97, 13
    s_and_b32 s62, s62, 15
    s_lshl_b32 s6, s62, 12
    s_add_u32 m0, s58, s6
    s_lshl_b32 s6, s62, 15
    buffer_load_dwordx4 v15, s[16:19], s6 offen lds
    s_add_u32 s62, s97, 14
    s_and_b32 s62, s62, 15
    s_lshl_b32 s6, s62, 12
    s_add_u32 m0, s58, s6
    s_lshl_b32 s6, s62, 15
    buffer_load_dwordx4 v15, s[16:19], s6 offen lds
    s_add_u32 s62, s97, 15
    s_and_b32 s62, s62, 15
    s_lshl_b32 s6, s62, 12
    s_add_u32 m0, s58, s6
    s_lshl_b32 s6, s62, 15
    buffer_load_dwordx4 v15, s[16:19], s6 offen lds
    s_add_u32 s8, s56, 0x500000
    s_addc_u32 s9, s57, 0
    s_mov_b32 s10, 0x10000
    s_mov_b32 s11, 0x20000
    v_mov_b32 v8, v21
    s_mov_b32 s7, s100
    s_add_u32 s6, s7, 24576
    s_waitcnt vmcnt(0)
    s_mov_b64 exec, 1
    ds_add_u32 v17, v18 offset:8
    s_mov_b64 exec, -1
    s_bitcmp1_b32 s33, 0
    s_cbranch_scc1 K_A_ODD
    s_branch K_A_EVEN
K_B:
    s_and_b32 s5, s5, 7
    s_lshl_b32 s29, s4, 2
    s_lshr_b32 s6, s5, 1
    s_add_u32 s29, s29, s6
    v_lshlrev_b32 v36, 4, v2
    s_lshr_b32 s32, s3, 1
    s_and_b32 s33, s3, 1
    s_lshl_b32 s35, s3, 13
    v_mov_b32 v14, 0
    v_mov_b32 v15, 1
    v_lshlrev_b32 v16, 7, v2
    s_cmp_ge_u32 s3, 4
    s_cbranch_scc1 K_B_GEN
    s_and_b32 s97, s5, 1
    s_lshl_b32 s97, s97, 2
    s_add_u32 s97, s97, s3
    v_and_b32 v37, 1, v4
    v_lshlrev_b32 v37, 5, v37
    v_xor_b32 v37, v37, v36
    s_lshl_b32 s6, s29, 2
    s_lshr_b32 s7, s97, 1
    s_add_u32 s6, s6, s7
    s_lshl_b32 s7, s33, 10
    s_add_u32 s6, s6, s7
    s_lshl_b32 s34, s6, 10
    s_lshl_b32 s97, s97, 13
    s_mov_b32 s7, 0
    s_waitcnt lgkmcnt(0)
    s_mov_b32 s20, s42
    s_mov_b32 s21, s43
    s_mov_b32 s22, 0x200000
    s_mov_b32 s23, 0x20000
    s_mov_b32 s12, s38
    s_mov_b32 s13, s39
    s_mov_b32 s14, 0x180000
    s_mov_b32 s15, 0x20000
    s_lshl_b32 s59, s5, 2
    s_add_u32 s59, s59, s3
    s_lshl_b32 s59, s59, 13
    s_mul_i32 s28, s4, 1
    s_add_u32 s28, s28, 3
    s_and_b32 s28, s28, 7
    s_mul_i32 s28, s28, 196608
    s_add_u32 s59, s59, s28
    v_lshlrev_b32 v10, 10, v5
    v_lshl_add_u32 v10, v6, 4, v10
    s_sub_u32 s28, s59, 0x180000
    s_cselect_b32 s59, s59, s28
    buffer_load_dwordx4 v[244:247], v10, s[12:15], s59 offen offset:384
    s_add_u32 s59, s59, 0x40000
    s_add_u32 m0, s97, 0
    s_add_u32 s6, s34, 0
    buffer_load_dwordx4 v37, s[20:23], s6 offen lds
    s_add_u32 m0, s97, 1024
    s_add_u32 s6, s34, 131072
    buffer_load_dwordx4 v37, s[20:23], s6 offen lds
    s_add_u32 m0, s97, 2048
    s_add_u32 s6, s34, 262144
    buffer_load_dwordx4 v37, s[20:23], s6 offen lds
    s_add_u32 m0, s97, 3072
    s_add_u32 s6, s34, 393216
    buffer_load_dwordx4 v37, s[20:23], s6 offen lds
    s_add_u32 m0, s97, 4096
    s_add_u32 s6, s34, 524288
    buffer_load_dwordx4 v37, s[20:23], s6 offen lds
    s_add_u32 m0, s97, 5120
    s_add_u32 s6, s34, 655360
    buffer_load_dwordx4 v37, s[20:23], s6 offen lds
    s_add_u32 m0, s97, 6144
    s_add_u32 s6, s34, 786432
    buffer_load_dwordx4 v37, s[20:23], s6 offen lds
    s_add_u32 m0, s97, 7168
    s_add_u32 s6, s34, 917504
    buffer_load_dwordx4 v37, s[20:23], s6 offen lds
    s_branch K_B_GEN
    s_nop 0
.fill 142, 4, 0xbf800000
K_A_EVEN:
K_A_LWE:
    ds_read_b32 v9, v17 offset:8
    s_waitcnt lgkmcnt(0)
    v_cmp_ne_u32 vcc, 8, v9
    s_cmp_lg_u64 vcc, 0
    s_cbranch_scc1 K_A_LWE
    ds_read_b64_tr_b16 v[36:37], v24 offset:0
    ds_read_b64_tr_b16 v[38:39], v24 offset:512
    ds_read_b64_tr_b16 v[40:41], v25 offset:0
    ds_read_b64_tr_b16 v[42:43], v25 offset:512
    ds_read_b64_tr_b16 v[44:45], v26 offset:0
    ds_read_b64_tr_b16 v[46:47], v26 offset:512
    ds_read_b64_tr_b16 v[48:49], v27 offset:0
    ds_read_b64_tr_b16 v[50:51], v27 offset:512
    ds_read_b64_tr_b16 v[52:53], v24 offset:4096
    ds_read_b64_tr_b16 v[54:55], v24 offset:4608
    ds_read_b64_tr_b16 v[56:57], v25 offset:4096
    ds_read_b64_tr_b16 v[58:59], v25 offset:4608
    ds_read_b64_tr_b16 v[60:61], v26 offset:4096
    ds_read_b64_tr_b16 v[62:63], v26 offset:4608
    ds_read_b64_tr_b16 v[64:65], v27 offset:4096
    ds_read_b64_tr_b16 v[66:67], v27 offset:4608
    ds_read_b64_tr_b16 v[68:69], v24 offset:8192
    ds_read_b64_tr_b16 v[70:71], v24 offset:8704
    ds_read_b64_tr_b16 v[72:73], v25 offset:8192
    ds_read_b64_tr_b16 v[74:75], v25 offset:8704
    ds_read_b64_tr_b16 v[76:77], v26 offset:8192
    ds_read_b64_tr_b16 v[78:79], v26 offset:8704
    ds_read_b64_tr_b16 v[80:81], v27 offset:8192
    ds_read_b64_tr_b16 v[82:83], v27 offset:8704
    ds_read_b64_tr_b16 v[84:85], v24 offset:12288
    ds_read_b64_tr_b16 v[86:87], v24 offset:12800
    ds_read_b64_tr_b16 v[88:89], v25 offset:12288
    ds_read_b64_tr_b16 v[90:91], v25 offset:12800
    ds_read_b64_tr_b16 v[92:93], v26 offset:12288
    ds_read_b64_tr_b16 v[94:95], v26 offset:12800
    ds_read_b64_tr_b16 v[96:97], v27 offset:12288
    ds_read_b64_tr_b16 v[98:99], v27 offset:12800
    ds_read_b64_tr_b16 v[100:101], v24 offset:16384
    ds_read_b64_tr_b16 v[102:103], v24 offset:16896
    ds_read_b64_tr_b16 v[104:105], v25 offset:16384
    ds_read_b64_tr_b16 v[106:107], v25 offset:16896
    ds_read_b64_tr_b16 v[108:109], v26 offset:16384
    ds_read_b64_tr_b16 v[110:111], v26 offset:16896
    ds_read_b64_tr_b16 v[112:113], v27 offset:16384
    ds_read_b64_tr_b16 v[114:115], v27 offset:16896
    ds_read_b64_tr_b16 v[116:117], v24 offset:20480
    ds_read_b64_tr_b16 v[118:119], v24 offset:20992
    ds_read_b64_tr_b16 v[120:121], v25 offset:20480
    ds_read_b64_tr_b16 v[122:123], v25 offset:20992
    ds_read_b64_tr_b16 v[124:125], v26 offset:20480
    ds_read_b64_tr_b16 v[126:127], v26 offset:20992
    ds_read_b64_tr_b16 v[128:129], v27 offset:20480
    ds_read_b64_tr_b16 v[130:131], v27 offset:20992
    ds_read_b64_tr_b16 v[132:133], v24 offset:32768
    ds_read_b64_tr_b16 v[134:135], v24 offset:33280
    ds_read_b64_tr_b16 v[136:137], v25 offset:32768
    ds_read_b64_tr_b16 v[138:139], v25 offset:33280
    ds_read_b64_tr_b16 v[140:141], v26 offset:32768
    ds_read_b64_tr_b16 v[142:143], v26 offset:33280
    ds_read_b64_tr_b16 v[144:145], v27 offset:32768
    ds_read_b64_tr_b16 v[146:147], v27 offset:33280
    ds_read_b64_tr_b16 v[148:149], v24 offset:36864
    ds_read_b64_tr_b16 v[150:151], v24 offset:37376
    ds_read_b64_tr_b16 v[152:153], v25 offset:36864
    ds_read_b64_tr_b16 v[154:155], v25 offset:37376
    ds_read_b64_tr_b16 v[156:157], v26 offset:36864
    ds_read_b64_tr_b16 v[158:159], v26 offset:37376
    ds_read_b64_tr_b16 v[160:161], v27 offset:36864
    ds_read_b64_tr_b16 v[162:163], v27 offset:37376
    ds_read_b64_tr_b16 v[164:165], v24 offset:40960
    ds_read_b64_tr_b16 v[166:167], v24 offset:41472
    ds_read_b64_tr_b16 v[168:169], v25 offset:40960
    ds_read_b64_tr_b16 v[170:171], v25 offset:41472
    ds_read_b64_tr_b16 v[172:173], v26 offset:40960
    ds_read_b64_tr_b16 v[174:175], v26 offset:41472
    ds_read_b64_tr_b16 v[176:177], v27 offset:40960
    ds_read_b64_tr_b16 v[178:179], v27 offset:41472
    s_mov_b32 s28, 0
    s_mov_b32 s99, 0
    s_mov_b32 s94, 0xf7f7f7f7
    s_mov_b32 s95, 0xf7f7f7f7
    s_mov_b64 exec, 0xff
K_A_P1AE:
    buffer_load_dwordx4 v[12:15], v8, s[8:11], s100 offen sc1
    s_add_u32 s28, s28, 1
    s_waitcnt vmcnt(0)
    v_and_b32 v12, v12, v13
    v_and_b32 v14, v14, v15
    v_and_b32 v9, v12, v14
    v_cmp_ne_u32 vcc, s96, v9
    s_cmp_eq_u64 vcc, 0
    s_cbranch_scc1 K_A_GOAE
    s_cmp_lt_u32 s28, 60
    s_cbranch_scc1 K_A_P1AE
    ds_write_b32 v17, v18
    s_mov_b32 s99, 1
    s_mov_b64 s[92:93], 0
    s_waitcnt lgkmcnt(0)
    s_barrier
K_A_P2AE:
    buffer_load_dwordx4 v[12:15], v8, s[8:11], s100 offen sc1
    buffer_load_dword v10, v8, s[8:11], s6 offen sc1
    s_add_u32 s28, s28, 1
    s_waitcnt vmcnt(0)
    v_and_b32 v12, v12, v13
    v_and_b32 v14, v14, v15
    v_and_b32 v9, v12, v14
    v_cmp_ne_u32 vcc, s96, v9
    s_cmp_eq_u64 vcc, 0
    s_cbranch_scc1 K_A_GOAE
    v_cmp_ne_u32 vcc, 1, v10
    s_cmp_eq_u64 vcc, 0
    s_cbranch_scc1 K_A_GOAE
    s_cmp_lt_u32 s28, 400000
    s_cbranch_scc1 K_A_P2AE
K_A_GOAE:
    s_mov_b64 exec, -1
    s_add_u32 s7, s43, 0
    buffer_load_dwordx4 v[180:183], v33, s[20:23], s7 offen offset:0 sc1
    s_add_u32 s7, s43, 0
    buffer_load_dwordx4 v[184:187], v33, s[20:23], s7 offen offset:1024 sc1
    s_add_u32 s7, s43, 0
    buffer_load_dwordx4 v[188:191], v33, s[20:23], s7 offen offset:2048 sc1
    s_add_u32 s7, s43, 0
    buffer_load_dwordx4 v[192:195], v33, s[20:23], s7 offen offset:3072 sc1
    s_add_u32 s7, s43, 4096
    buffer_load_dwordx4 v[196:199], v33, s[20:23], s7 offen offset:0 sc1
    s_add_u32 s7, s43, 4096
    buffer_load_dwordx4 v[200:203], v33, s[20:23], s7 offen offset:1024 sc1
    s_add_u32 s7, s43, 8192
    buffer_load_dwordx4 v[204:207], v33, s[20:23], s7 offen offset:0 sc1
    s_add_u32 s7, s43, 8192
    buffer_load_dwordx4 v[208:211], v33, s[20:23], s7 offen offset:1024 sc1
    s_add_u32 s7, s43, 8192
    buffer_load_dwordx4 v[212:215], v33, s[20:23], s7 offen offset:2048 sc1
    s_add_u32 s7, s42, 8192
    buffer_load_dwordx4 v[216:219], v33, s[20:23], s7 offen offset:2048 sc1
    s_waitcnt vmcnt(9) lgkmcnt(0)
    v_mfma_f32_16x16x32_bf16 v[220:223], v[36:39], v[180:183], 0
    v_mfma_f32_16x16x32_bf16 v[224:227], v[40:43], v[180:183], 0
    v_mfma_f32_16x16x32_bf16 v[228:231], v[44:47], v[180:183], 0
    v_mfma_f32_16x16x32_bf16 v[232:235], v[48:51], v[180:183], 0
    s_waitcnt vmcnt(8)
    v_mfma_f32_16x16x32_bf16 v[220:223], v[52:55], v[184:187], v[220:223]
    s_add_u32 s7, s43, 8192
    buffer_load_dwordx4 v[180:183], v33, s[20:23], s7 offen offset:3072 sc1
    v_mfma_f32_16x16x32_bf16 v[224:227], v[56:59], v[184:187], v[224:227]
    v_mfma_f32_16x16x32_bf16 v[228:231], v[60:63], v[184:187], v[228:231]
    v_mfma_f32_16x16x32_bf16 v[232:235], v[64:67], v[184:187], v[232:235]
    s_waitcnt vmcnt(8)
    v_mfma_f32_16x16x32_bf16 v[220:223], v[68:71], v[188:191], v[220:223]
    s_add_u32 s7, s42, 8192
    buffer_load_dwordx4 v[184:187], v33, s[20:23], s7 offen offset:3072 sc1
    v_mfma_f32_16x16x32_bf16 v[224:227], v[72:75], v[188:191], v[224:227]
    v_mfma_f32_16x16x32_bf16 v[228:231], v[76:79], v[188:191], v[228:231]
    v_mfma_f32_16x16x32_bf16 v[232:235], v[80:83], v[188:191], v[232:235]
    s_waitcnt vmcnt(8)
    v_mfma_f32_16x16x32_bf16 v[220:223], v[84:87], v[192:195], v[220:223]
    s_add_u32 s7, s43, 12288
    buffer_load_dwordx4 v[188:191], v33, s[20:23], s7 offen offset:0 sc1
    v_mfma_f32_16x16x32_bf16 v[224:227], v[88:91], v[192:195], v[224:227]
    v_mfma_f32_16x16x32_bf16 v[228:231], v[92:95], v[192:195], v[228:231]
    v_mfma_f32_16x16x32_bf16 v[232:235], v[96:99], v[192:195], v[232:235]
    s_waitcnt vmcnt(8)
    v_mfma_f32_16x16x32_bf16 v[220:223], v[100:103], v[196:199], v[220:223]
    s_add_u32 s7, s42, 12288
    buffer_load_dwordx4 v[192:195], v33, s[20:23], s7 offen offset:0 sc1
    v_mfma_f32_16x16x32_bf16 v[224:227], v[104:107], v[196:199], v[224:227]
    v_mfma_f32_16x16x32_bf16 v[228:231], v[108:111], v[196:199], v[228:231]
    v_mfma_f32_16x16x32_bf16 v[232:235], v[112:115], v[196:199], v[232:235]
    s_waitcnt vmcnt(8)
    v_mfma_f32_16x16x32_bf16 v[220:223], v[116:119], v[200:203], v[220:223]
    s_add_u32 s7, s43, 12288
    buffer_load_dwordx4 v[196:199], v33, s[20:23], s7 offen offset:1024 sc1
    v_mfma_f32_16x16x32_bf16 v[224:227], v[120:123], v[200:203], v[224:227]
    v_mfma_f32_16x16x32_bf16 v[228:231], v[124:127], v[200:203], v[228:231]
    v_mfma_f32_16x16x32_bf16 v[232:235], v[128:131], v[200:203], v[232:235]
    s_waitcnt vmcnt(8)
    v_mfma_f32_16x16x32_bf16 v[220:223], v[132:135], v[204:207], v[220:223]
    s_add_u32 s7, s42, 12288
    buffer_load_dwordx4 v[200:203], v33, s[20:23], s7 offen offset:1024 sc1
    v_mfma_f32_16x16x32_bf16 v[224:227], v[136:139], v[204:207], v[224:227]
    v_mfma_f32_16x16x32_bf16 v[228:231], v[140:143], v[204:207], v[228:231]
    v_mfma_f32_16x16x32_bf16 v[232:235], v[144:147], v[204:207], v[232:235]
    s_waitcnt vmcnt(8)
    v_mfma_f32_16x16x32_bf16 v[220:223], v[148:151], v[208:211], v[220:223]
    s_add_u32 s7, s43, 12288
    buffer_load_dwordx4 v[204:207], v33, s[20:23], s7 offen offset:2048 sc1
    v_mfma_f32_16x16x32_bf16 v[224:227], v[152:155], v[208:211], v[224:227]
    ds_read_b64_tr_b16 v[36:37], v24 offset:45056
    ds_read_b64_tr_b16 v[38:39], v24 offset:45568
    v_mfma_f32_16x16x32_bf16 v[228:231], v[156:159], v[208:211], v[228:231]
    ds_read_b64_tr_b16 v[40:41], v25 offset:45056
    ds_read_b64_tr_b16 v[42:43], v25 offset:45568
    v_mfma_f32_16x16x32_bf16 v[232:235], v[160:163], v[208:211], v[232:235]
    ds_read_b64_tr_b16 v[44:45], v26 offset:45056
    ds_read_b64_tr_b16 v[46:47], v26 offset:45568
    ds_read_b64_tr_b16 v[48:49], v27 offset:45056
    ds_read_b64_tr_b16 v[50:51], v27 offset:45568
    s_waitcnt vmcnt(7)
    v_mfma_f32_16x16x32_bf16 v[220:223], v[164:167], v[212:215], v[220:223]
    s_add_u32 s7, s42, 12288
    buffer_load_dwordx4 v[208:211], v33, s[20:23], s7 offen offset:2048 sc1
    v_mfma_f32_16x16x32_bf16 v[224:227], v[168:171], v[212:215], v[224:227]
    ds_read_b64_tr_b16 v[52:53], v24 offset:49152
    ds_read_b64_tr_b16 v[54:55], v24 offset:49664
    v_mfma_f32_16x16x32_bf16 v[228:231], v[172:175], v[212:215], v[228:231]
    ds_read_b64_tr_b16 v[56:57], v25 offset:49152
    ds_read_b64_tr_b16 v[58:59], v25 offset:49664
    v_mfma_f32_16x16x32_bf16 v[232:235], v[176:179], v[212:215], v[232:235]
    ds_read_b64_tr_b16 v[60:61], v26 offset:49152
    ds_read_b64_tr_b16 v[62:63], v26 offset:49664
    v_mfma_f32_16x16x32_bf16 v[236:239], v[164:167], v[216:219], 0
    ds_read_b64_tr_b16 v[64:65], v27 offset:49152
    ds_read_b64_tr_b16 v[66:67], v27 offset:49664
    v_mfma_f32_16x16x32_bf16 v[240:243], v[168:171], v[216:219], 0
    v_mfma_f32_16x16x32_bf16 v[244:247], v[172:175], v[216:219], 0
    v_mfma_f32_16x16x32_bf16 v[248:251], v[176:179], v[216:219], 0
    s_waitcnt vmcnt(6) lgkmcnt(8)
    v_mfma_f32_16x16x32_bf16 v[220:223], v[36:39], v[180:183], v[220:223]
    s_add_u32 s7, s43, 12288
    buffer_load_dwordx4 v[212:215], v33, s[20:23], s7 offen offset:3072 sc1
    v_mfma_f32_16x16x32_bf16 v[224:227], v[40:43], v[180:183], v[224:227]
    s_add_u32 s7, s42, 12288
    buffer_load_dwordx4 v[216:219], v33, s[20:23], s7 offen offset:3072 sc1
    v_mfma_f32_16x16x32_bf16 v[228:231], v[44:47], v[180:183], v[228:231]
    ds_read_b64_tr_b16 v[68:69], v24 offset:53248
    ds_read_b64_tr_b16 v[70:71], v24 offset:53760
    v_mfma_f32_16x16x32_bf16 v[232:235], v[48:51], v[180:183], v[232:235]
    ds_read_b64_tr_b16 v[72:73], v25 offset:53248
    ds_read_b64_tr_b16 v[74:75], v25 offset:53760
    v_mfma_f32_16x16x32_bf16 v[236:239], v[36:39], v[184:187], v[236:239]
    ds_read_b64_tr_b16 v[76:77], v26 offset:53248
    ds_read_b64_tr_b16 v[78:79], v26 offset:53760
    v_mfma_f32_16x16x32_bf16 v[240:243], v[40:43], v[184:187], v[240:243]
    ds_read_b64_tr_b16 v[80:81], v27 offset:53248
    ds_read_b64_tr_b16 v[82:83], v27 offset:53760
    v_mfma_f32_16x16x32_bf16 v[244:247], v[44:47], v[184:187], v[244:247]
    v_mfma_f32_16x16x32_bf16 v[248:251], v[48:51], v[184:187], v[248:251]
    s_waitcnt vmcnt(6) lgkmcnt(8)
    v_mfma_f32_16x16x32_bf16 v[220:223], v[52:55], v[188:191], v[220:223]
    s_add_u32 s7, s43, 4096
    buffer_load_dwordx4 v[180:183], v33, s[20:23], s7 offen offset:2048 sc1
    v_mfma_f32_16x16x32_bf16 v[224:227], v[56:59], v[188:191], v[224:227]
    s_add_u32 s7, s42, 4096
    buffer_load_dwordx4 v[184:187], v33, s[20:23], s7 offen offset:2048 sc1
    v_mfma_f32_16x16x32_bf16 v[228:231], v[60:63], v[188:191], v[228:231]
    ds_read_b64_tr_b16 v[84:85], v24 offset:57344
    ds_read_b64_tr_b16 v[86:87], v24 offset:57856
    v_mfma_f32_16x16x32_bf16 v[232:235], v[64:67], v[188:191], v[232:235]
    ds_read_b64_tr_b16 v[88:89], v25 offset:57344
    ds_read_b64_tr_b16 v[90:91], v25 offset:57856
    v_mfma_f32_16x16x32_bf16 v[236:239], v[52:55], v[192:195], v[236:239]
    ds_read_b64_tr_b16 v[92:93], v26 offset:57344
    ds_read_b64_tr_b16 v[94:95], v26 offset:57856
    v_mfma_f32_16x16x32_bf16 v[240:243], v[56:59], v[192:195], v[240:243]
    ds_read_b64_tr_b16 v[96:97], v27 offset:57344
    ds_read_b64_tr_b16 v[98:99], v27 offset:57856
    v_mfma_f32_16x16x32_bf16 v[244:247], v[60:63], v[192:195], v[244:247]
    v_mfma_f32_16x16x32_bf16 v[248:251], v[64:67], v[192:195], v[248:251]
    s_waitcnt vmcnt(6) lgkmcnt(8)
    v_mfma_f32_16x16x32_bf16 v[220:223], v[68:71], v[196:199], v[220:223]
    s_add_u32 s7, s43, 4096
    buffer_load_dwordx4 v[188:191], v33, s[20:23], s7 offen offset:3072 sc1
    v_mfma_f32_16x16x32_bf16 v[224:227], v[72:75], v[196:199], v[224:227]
    s_add_u32 s7, s42, 4096
    buffer_load_dwordx4 v[192:195], v33, s[20:23], s7 offen offset:3072 sc1
    v_mfma_f32_16x16x32_bf16 v[228:231], v[76:79], v[196:199], v[228:231]
    ds_read_b64_tr_b16 v[100:101], v24 offset:61440
    ds_read_b64_tr_b16 v[102:103], v24 offset:61952
    v_mfma_f32_16x16x32_bf16 v[232:235], v[80:83], v[196:199], v[232:235]
    ds_read_b64_tr_b16 v[104:105], v25 offset:61440
    ds_read_b64_tr_b16 v[106:107], v25 offset:61952
    v_mfma_f32_16x16x32_bf16 v[236:239], v[68:71], v[200:203], v[236:239]
    ds_read_b64_tr_b16 v[108:109], v26 offset:61440
    ds_read_b64_tr_b16 v[110:111], v26 offset:61952
    v_mfma_f32_16x16x32_bf16 v[240:243], v[72:75], v[200:203], v[240:243]
    ds_read_b64_tr_b16 v[112:113], v27 offset:61440
    ds_read_b64_tr_b16 v[114:115], v27 offset:61952
    v_mfma_f32_16x16x32_bf16 v[244:247], v[76:79], v[200:203], v[244:247]
    v_mfma_f32_16x16x32_bf16 v[248:251], v[80:83], v[200:203], v[248:251]
    s_waitcnt vmcnt(6) lgkmcnt(8)
    v_mfma_f32_16x16x32_bf16 v[220:223], v[84:87], v[204:207], v[220:223]
    ds_read_b64_tr_b16 v[116:117], v24 offset:24576
    ds_read_b64_tr_b16 v[118:119], v24 offset:25088
    v_mfma_f32_16x16x32_bf16 v[224:227], v[88:91], v[204:207], v[224:227]
    ds_read_b64_tr_b16 v[120:121], v25 offset:24576
    ds_read_b64_tr_b16 v[122:123], v25 offset:25088
    v_mfma_f32_16x16x32_bf16 v[228:231], v[92:95], v[204:207], v[228:231]
    ds_read_b64_tr_b16 v[124:125], v26 offset:24576
    ds_read_b64_tr_b16 v[126:127], v26 offset:25088
    v_mfma_f32_16x16x32_bf16 v[232:235], v[96:99], v[204:207], v[232:235]
    ds_read_b64_tr_b16 v[128:129], v27 offset:24576
    ds_read_b64_tr_b16 v[130:131], v27 offset:25088
    v_mfma_f32_16x16x32_bf16 v[236:239], v[84:87], v[208:211], v[236:239]
    v_mfma_f32_16x16x32_bf16 v[240:243], v[88:91], v[208:211], v[240:243]
    v_mfma_f32_16x16x32_bf16 v[244:247], v[92:95], v[208:211], v[244:247]
    v_mfma_f32_16x16x32_bf16 v[248:251], v[96:99], v[208:211], v[248:251]
    s_waitcnt vmcnt(4) lgkmcnt(8)
    v_mfma_f32_16x16x32_bf16 v[220:223], v[100:103], v[212:215], v[220:223]
    ds_read_b64_tr_b16 v[132:133], v24 offset:28672
    ds_read_b64_tr_b16 v[134:135], v24 offset:29184
    v_mfma_f32_16x16x32_bf16 v[224:227], v[104:107], v[212:215], v[224:227]
    ds_read_b64_tr_b16 v[136:137], v25 offset:28672
    ds_read_b64_tr_b16 v[138:139], v25 offset:29184
    v_mfma_f32_16x16x32_bf16 v[228:231], v[108:111], v[212:215], v[228:231]
    ds_read_b64_tr_b16 v[140:141], v26 offset:28672
    ds_read_b64_tr_b16 v[142:143], v26 offset:29184
    v_mfma_f32_16x16x32_bf16 v[232:235], v[112:115], v[212:215], v[232:235]
    ds_read_b64_tr_b16 v[144:145], v27 offset:28672
    ds_read_b64_tr_b16 v[146:147], v27 offset:29184
    v_mfma_f32_16x16x32_bf16 v[236:239], v[100:103], v[216:219], v[236:239]
    v_mfma_f32_16x16x32_bf16 v[240:243], v[104:107], v[216:219], v[240:243]
    v_mfma_f32_16x16x32_bf16 v[244:247], v[108:111], v[216:219], v[244:247]
    v_mfma_f32_16x16x32_bf16 v[248:251], v[112:115], v[216:219], v[248:251]
    s_waitcnt vmcnt(2) lgkmcnt(8)
    v_mfma_f32_16x16x32_bf16 v[220:223], v[116:119], v[180:183], v[220:223]
    ds_read_b32 v10, v29 offset:16
    v_mfma_f32_16x16x32_bf16 v[224:227], v[120:123], v[180:183], v[224:227]
    v_mfma_f32_16x16x32_bf16 v[228:231], v[124:127], v[180:183], v[228:231]
    v_mfma_f32_16x16x32_bf16 v[232:235], v[128:131], v[180:183], v[232:235]
    v_mfma_f32_16x16x32_bf16 v[236:239], v[116:119], v[184:187], v[236:239]
    v_mfma_f32_16x16x32_bf16 v[240:243], v[120:123], v[184:187], v[240:243]
    v_mfma_f32_16x16x32_bf16 v[244:247], v[124:127], v[184:187], v[244:247]
    v_mfma_f32_16x16x32_bf16 v[248:251], v[128:131], v[184:187], v[248:251]
    s_waitcnt vmcnt(0) lgkmcnt(0)
    s_mov_b32 s28, 0
K_A_PW:
    v_cmp_ne_u32 vcc, 1, v10
    s_cmp_eq_u64 vcc, 0
    s_cbranch_scc1 K_A_PWX
    ds_read_b32 v10, v29 offset:16
    s_add_u32 s28, s28, 1
    s_cmp_lg_u32 s28, 64
    s_cbranch_scc1 K_A_PWN
    s_cmp_lg_u32 s99, 0
    s_cbranch_scc1 K_A_PWN
    s_mov_b32 s99, 1
    s_barrier
K_A_PWN:
    s_waitcnt lgkmcnt(0)
    s_branch K_A_PW
K_A_PWX:
    v_mfma_f32_16x16x32_bf16 v[220:223], v[132:135], v[188:191], v[220:223]
    ds_read_b128 v[148:151], v28 offset:0
    v_mfma_f32_16x16x32_bf16 v[224:227], v[136:139], v[188:191], v[224:227]
    ds_read_b128 v[152:155], v28 offset:1024
    v_mfma_f32_16x16x32_bf16 v[228:231], v[140:143], v[188:191], v[228:231]
    ds_read_b128 v[156:159], v28 offset:2048
    v_mfma_f32_16x16x32_bf16 v[232:235], v[144:147], v[188:191], v[232:235]
    ds_read_b128 v[160:163], v28 offset:3072
    v_mfma_f32_16x16x32_bf16 v[236:239], v[132:135], v[192:195], v[236:239]
    v_mfma_f32_16x16x32_bf16 v[240:243], v[136:139], v[192:195], v[240:243]
    v_mfma_f32_16x16x32_bf16 v[244:247], v[140:143], v[192:195], v[244:247]
    v_mfma_f32_16x16x32_bf16 v[248:251], v[144:147], v[192:195], v[248:251]
    s_nop 3
    v_cvt_pk_bf16_f32 v36, v220, v221
    v_cvt_pk_bf16_f32 v37, v222, v223
    ds_write_b64 v30, v[36:37] offset:0
    v_cvt_pk_bf16_f32 v38, v224, v225
    v_cvt_pk_bf16_f32 v39, v226, v227
    ds_write_b64 v30, v[38:39] offset:32
    v_cvt_pk_bf16_f32 v40, v228, v229
    v_cvt_pk_bf16_f32 v41, v230, v231
    ds_write_b64 v30, v[40:41] offset:64
    v_cvt_pk_bf16_f32 v42, v232, v233
    v_cvt_pk_bf16_f32 v43, v234, v235
    ds_write_b64 v30, v[42:43] offset:96
    ds_read_b128 v[52:55], v31 offset:0
    ds_read_b128 v[56:59], v31 offset:1152
    s_waitcnt lgkmcnt(6)
    v_add_f32 v236, v236, v148
    v_add_f32 v237, v237, v149
    v_add_f32 v238, v238, v150
    v_add_f32 v239, v239, v151
    v_add_f32 v240, v240, v152
    v_add_f32 v241, v241, v153
    v_add_f32 v242, v242, v154
    v_add_f32 v243, v243, v155
    v_add_f32 v244, v244, v156
    v_add_f32 v245, v245, v157
    v_add_f32 v246, v246, v158
    v_add_f32 v247, v247, v159
    v_add_f32 v248, v248, v160
    v_add_f32 v249, v249, v161
    v_add_f32 v250, v250, v162
    v_add_f32 v251, v251, v163
    v_cvt_pk_bf16_f32 v44, v236, v237
    v_cvt_pk_bf16_f32 v45, v238, v239
    ds_write_b64 v30, v[44:45] offset:2304
    v_cvt_pk_bf16_f32 v46, v240, v241
    v_cvt_pk_bf16_f32 v47, v242, v243
    ds_write_b64 v30, v[46:47] offset:2336
    v_cvt_pk_bf16_f32 v48, v244, v245
    v_cvt_pk_bf16_f32 v49, v246, v247
    ds_write_b64 v30, v[48:49] offset:2368
    v_cvt_pk_bf16_f32 v50, v248, v249
    v_cvt_pk_bf16_f32 v51, v250, v251
    ds_write_b64 v30, v[50:51] offset:2400
    ds_read_b128 v[60:63], v31 offset:2304
    ds_read_b128 v[64:67], v31 offset:3456
    s_waitcnt lgkmcnt(7)
    buffer_store_dwordx4 v[52:55], v32, s[44:47], s48 offen sc1
    s_waitcnt lgkmcnt(6)
    buffer_store_dwordx4 v[56:59], v32, s[44:47], s49 offen sc1
    s_waitcnt lgkmcnt(1)
    buffer_store_dwordx4 v[60:63], v32, s[44:47], s50 offen sc1
    s_waitcnt lgkmcnt(0)
    buffer_store_dwordx4 v[64:67], v32, s[44:47], s51 offen sc1
    s_cmp_lg_u32 s99, 0
    s_cbranch_scc1 K_A_NOBE
    s_barrier
K_A_NOBE:
    s_endpgm
.fill 302, 4, 0xbf800000
K_A_ODD:
K_A_LWO:
    ds_read_b32 v9, v17 offset:8
    s_waitcnt lgkmcnt(0)
    v_cmp_ne_u32 vcc, 8, v9
    s_cmp_lg_u64 vcc, 0
    s_cbranch_scc1 K_A_LWO
    ds_read_b64_tr_b16 v[36:37], v24 offset:0
    ds_read_b64_tr_b16 v[38:39], v24 offset:512
    ds_read_b64_tr_b16 v[40:41], v25 offset:0
    ds_read_b64_tr_b16 v[42:43], v25 offset:512
    ds_read_b64_tr_b16 v[44:45], v26 offset:0
    ds_read_b64_tr_b16 v[46:47], v26 offset:512
    ds_read_b64_tr_b16 v[48:49], v27 offset:0
    ds_read_b64_tr_b16 v[50:51], v27 offset:512
    ds_read_b64_tr_b16 v[52:53], v24 offset:4096
    ds_read_b64_tr_b16 v[54:55], v24 offset:4608
    ds_read_b64_tr_b16 v[56:57], v25 offset:4096
    ds_read_b64_tr_b16 v[58:59], v25 offset:4608
    ds_read_b64_tr_b16 v[60:61], v26 offset:4096
    ds_read_b64_tr_b16 v[62:63], v26 offset:4608
    ds_read_b64_tr_b16 v[64:65], v27 offset:4096
    ds_read_b64_tr_b16 v[66:67], v27 offset:4608
    ds_read_b64_tr_b16 v[68:69], v24 offset:8192
    ds_read_b64_tr_b16 v[70:71], v24 offset:8704
    ds_read_b64_tr_b16 v[72:73], v25 offset:8192
    ds_read_b64_tr_b16 v[74:75], v25 offset:8704
    ds_read_b64_tr_b16 v[76:77], v26 offset:8192
    ds_read_b64_tr_b16 v[78:79], v26 offset:8704
    ds_read_b64_tr_b16 v[80:81], v27 offset:8192
    ds_read_b64_tr_b16 v[82:83], v27 offset:8704
    ds_read_b64_tr_b16 v[84:85], v24 offset:12288
    ds_read_b64_tr_b16 v[86:87], v24 offset:12800
    ds_read_b64_tr_b16 v[88:89], v25 offset:12288
    ds_read_b64_tr_b16 v[90:91], v25 offset:12800
    ds_read_b64_tr_b16 v[92:93], v26 offset:12288
    ds_read_b64_tr_b16 v[94:95], v26 offset:12800
    ds_read_b64_tr_b16 v[96:97], v27 offset:12288
    ds_read_b64_tr_b16 v[98:99], v27 offset:12800
    ds_read_b64_tr_b16 v[100:101], v24 offset:16384
    ds_read_b64_tr_b16 v[102:103], v24 offset:16896
    ds_read_b64_tr_b16 v[104:105], v25 offset:16384
    ds_read_b64_tr_b16 v[106:107], v25 offset:16896
    ds_read_b64_tr_b16 v[108:109], v26 offset:16384
    ds_read_b64_tr_b16 v[110:111], v26 offset:16896
    ds_read_b64_tr_b16 v[112:113], v27 offset:16384
    ds_read_b64_tr_b16 v[114:115], v27 offset:16896
    ds_read_b64_tr_b16 v[116:117], v24 offset:20480
    ds_read_b64_tr_b16 v[118:119], v24 offset:20992
    ds_read_b64_tr_b16 v[120:121], v25 offset:20480
    ds_read_b64_tr_b16 v[122:123], v25 offset:20992
    ds_read_b64_tr_b16 v[124:125], v26 offset:20480
    ds_read_b64_tr_b16 v[126:127], v26 offset:20992
    ds_read_b64_tr_b16 v[128:129], v27 offset:20480
    ds_read_b64_tr_b16 v[130:131], v27 offset:20992
    ds_read_b64_tr_b16 v[132:133], v24 offset:32768
    ds_read_b64_tr_b16 v[134:135], v24 offset:33280
    ds_read_b64_tr_b16 v[136:137], v25 offset:32768
    ds_read_b64_tr_b16 v[138:139], v25 offset:33280
    ds_read_b64_tr_b16 v[140:141], v26 offset:32768
    ds_read_b64_tr_b16 v[142:143], v26 offset:33280
    ds_read_b64_tr_b16 v[144:145], v27 offset:32768
    ds_read_b64_tr_b16 v[146:147], v27 offset:33280
    ds_read_b64_tr_b16 v[148:149], v24 offset:36864
    ds_read_b64_tr_b16 v[150:151], v24 offset:37376
    ds_read_b64_tr_b16 v[152:153], v25 offset:36864
    ds_read_b64_tr_b16 v[154:155], v25 offset:37376
    ds_read_b64_tr_b16 v[156:157], v26 offset:36864
    ds_read_b64_tr_b16 v[158:159], v26 offset:37376
    ds_read_b64_tr_b16 v[160:161], v27 offset:36864
    ds_read_b64_tr_b16 v[162:163], v27 offset:37376
    ds_read_b64_tr_b16 v[164:165], v24 offset:40960
    ds_read_b64_tr_b16 v[166:167], v24 offset:41472
    ds_read_b64_tr_b16 v[168:169], v25 offset:40960
    ds_read_b64_tr_b16 v[170:171], v25 offset:41472
    ds_read_b64_tr_b16 v[172:173], v26 offset:40960
    ds_read_b64_tr_b16 v[174:175], v26 offset:41472
    ds_read_b64_tr_b16 v[176:177], v27 offset:40960
    ds_read_b64_tr_b16 v[178:179], v27 offset:41472
    s_mov_b32 s28, 0
    s_mov_b32 s99, 0
    s_mov_b32 s94, 0xf7f7f7f7
    s_mov_b32 s95, 0xf7f7f7f7
    s_mov_b64 exec, 0xff
K_A_P1AO:
    buffer_load_dwordx4 v[12:15], v8, s[8:11], s100 offen sc1
    s_add_u32 s28, s28, 1
    s_waitcnt vmcnt(0)
    v_and_b32 v12, v12, v13
    v_and_b32 v14, v14, v15
    v_and_b32 v9, v12, v14
    v_cmp_ne_u32 vcc, s96, v9
    s_cmp_eq_u64 vcc, 0
    s_cbranch_scc1 K_A_GOAO
    s_cmp_lt_u32 s28, 60
    s_cbranch_scc1 K_A_P1AO
    ds_write_b32 v17, v18
    s_mov_b32 s99, 1
    s_mov_b64 s[92:93], 0
    s_waitcnt lgkmcnt(0)
    s_barrier
K_A_P2AO:
    buffer_load_dwordx4 v[12:15], v8, s[8:11], s100 offen sc1
    buffer_load_dword v10, v8, s[8:11], s6 offen sc1
    s_add_u32 s28, s28, 1
    s_waitcnt vmcnt(0)
    v_and_b32 v12, v12, v13
    v_and_b32 v14, v14, v15
    v_and_b32 v9, v12, v14
    v_cmp_ne_u32 vcc, s96, v9
    s_cmp_eq_u64 vcc, 0
    s_cbranch_scc1 K_A_GOAO
    v_cmp_ne_u32 vcc, 1, v10
    s_cmp_eq_u64 vcc, 0
    s_cbranch_scc1 K_A_GOAO
    s_cmp_lt_u32 s28, 400000
    s_cbranch_scc1 K_A_P2AO
K_A_GOAO:
    s_mov_b64 exec, -1
    s_add_u32 s7, s43, 0
    buffer_load_dwordx4 v[180:183], v33, s[20:23], s7 offen offset:0 sc1
    s_add_u32 s7, s42, 0
    buffer_load_dwordx4 v[184:187], v33, s[20:23], s7 offen offset:0 sc1
    s_add_u32 s7, s43, 0
    buffer_load_dwordx4 v[188:191], v33, s[20:23], s7 offen offset:1024 sc1
    s_add_u32 s7, s42, 0
    buffer_load_dwordx4 v[192:195], v33, s[20:23], s7 offen offset:1024 sc1
    s_add_u32 s7, s43, 0
    buffer_load_dwordx4 v[196:199], v33, s[20:23], s7 offen offset:2048 sc1
    s_add_u32 s7, s42, 0
    buffer_load_dwordx4 v[200:203], v33, s[20:23], s7 offen offset:2048 sc1
    s_add_u32 s7, s43, 0
    buffer_load_dwordx4 v[204:207], v33, s[20:23], s7 offen offset:3072 sc1
    s_add_u32 s7, s42, 0
    buffer_load_dwordx4 v[208:211], v33, s[20:23], s7 offen offset:3072 sc1
    s_add_u32 s7, s43, 4096
    buffer_load_dwordx4 v[212:215], v33, s[20:23], s7 offen offset:0 sc1
    s_add_u32 s7, s42, 4096
    buffer_load_dwordx4 v[216:219], v33, s[20:23], s7 offen offset:0 sc1
    s_waitcnt vmcnt(8) lgkmcnt(0)
    v_mfma_f32_16x16x32_bf16 v[220:223], v[36:39], v[180:183], 0
    v_mfma_f32_16x16x32_bf16 v[224:227], v[40:43], v[180:183], 0
    v_mfma_f32_16x16x32_bf16 v[228:231], v[44:47], v[180:183], 0
    v_mfma_f32_16x16x32_bf16 v[232:235], v[48:51], v[180:183], 0
    v_mfma_f32_16x16x32_bf16 v[236:239], v[36:39], v[184:187], 0
    v_mfma_f32_16x16x32_bf16 v[240:243], v[40:43], v[184:187], 0
    v_mfma_f32_16x16x32_bf16 v[244:247], v[44:47], v[184:187], 0
    v_mfma_f32_16x16x32_bf16 v[248:251], v[48:51], v[184:187], 0
    s_waitcnt vmcnt(6)
    v_mfma_f32_16x16x32_bf16 v[220:223], v[52:55], v[188:191], v[220:223]
    s_add_u32 s7, s43, 4096
    buffer_load_dwordx4 v[180:183], v33, s[20:23], s7 offen offset:1024 sc1
    v_mfma_f32_16x16x32_bf16 v[224:227], v[56:59], v[188:191], v[224:227]
    s_add_u32 s7, s42, 4096
    buffer_load_dwordx4 v[184:187], v33, s[20:23], s7 offen offset:1024 sc1
    v_mfma_f32_16x16x32_bf16 v[228:231], v[60:63], v[188:191], v[228:231]
    ds_read_b64_tr_b16 v[36:37], v24 offset:45056
    ds_read_b64_tr_b16 v[38:39], v24 offset:45568
    v_mfma_f32_16x16x32_bf16 v[232:235], v[64:67], v[188:191], v[232:235]
    ds_read_b64_tr_b16 v[40:41], v25 offset:45056
    ds_read_b64_tr_b16 v[42:43], v25 offset:45568
    v_mfma_f32_16x16x32_bf16 v[236:239], v[52:55], v[192:195], v[236:239]
    ds_read_b64_tr_b16 v[44:45], v26 offset:45056
    ds_read_b64_tr_b16 v[46:47], v26 offset:45568
    v_mfma_f32_16x16x32_bf16 v[240:243], v[56:59], v[192:195], v[240:243]
    ds_read_b64_tr_b16 v[48:49], v27 offset:45056
    ds_read_b64_tr_b16 v[50:51], v27 offset:45568
    v_mfma_f32_16x16x32_bf16 v[244:247], v[60:63], v[192:195], v[244:247]
    v_mfma_f32_16x16x32_bf16 v[248:251], v[64:67], v[192:195], v[248:251]
    s_waitcnt vmcnt(6)
    v_mfma_f32_16x16x32_bf16 v[220:223], v[68:71], v[196:199], v[220:223]
    s_add_u32 s7, s43, 8192
    buffer_load_dwordx4 v[188:191], v33, s[20:23], s7 offen offset:0 sc1
    v_mfma_f32_16x16x32_bf16 v[224:227], v[72:75], v[196:199], v[224:227]
    s_add_u32 s7, s42, 8192
    buffer_load_dwordx4 v[192:195], v33, s[20:23], s7 offen offset:0 sc1
    v_mfma_f32_16x16x32_bf16 v[228:231], v[76:79], v[196:199], v[228:231]
    ds_read_b64_tr_b16 v[52:53], v24 offset:49152
    ds_read_b64_tr_b16 v[54:55], v24 offset:49664
    v_mfma_f32_16x16x32_bf16 v[232:235], v[80:83], v[196:199], v[232:235]
    ds_read_b64_tr_b16 v[56:57], v25 offset:49152
    ds_read_b64_tr_b16 v[58:59], v25 offset:49664
    v_mfma_f32_16x16x32_bf16 v[236:239], v[68:71], v[200:203], v[236:239]
    ds_read_b64_tr_b16 v[60:61], v26 offset:49152
    ds_read_b64_tr_b16 v[62:63], v26 offset:49664
    v_mfma_f32_16x16x32_bf16 v[240:243], v[72:75], v[200:203], v[240:243]
    ds_read_b64_tr_b16 v[64:65], v27 offset:49152
    ds_read_b64_tr_b16 v[66:67], v27 offset:49664
    v_mfma_f32_16x16x32_bf16 v[244:247], v[76:79], v[200:203], v[244:247]
    v_mfma_f32_16x16x32_bf16 v[248:251], v[80:83], v[200:203], v[248:251]
    s_waitcnt vmcnt(6)
    v_mfma_f32_16x16x32_bf16 v[220:223], v[84:87], v[204:207], v[220:223]
    s_add_u32 s7, s43, 8192
    buffer_load_dwordx4 v[196:199], v33, s[20:23], s7 offen offset:1024 sc1
    v_mfma_f32_16x16x32_bf16 v[224:227], v[88:91], v[204:207], v[224:227]
    s_add_u32 s7, s42, 8192
    buffer_load_dwordx4 v[200:203], v33, s[20:23], s7 offen offset:1024 sc1
    v_mfma_f32_16x16x32_bf16 v[228:231], v[92:95], v[204:207], v[228:231]
    ds_read_b64_tr_b16 v[68:69], v24 offset:53248
    ds_read_b64_tr_b16 v[70:71], v24 offset:53760
    v_mfma_f32_16x16x32_bf16 v[232:235], v[96:99], v[204:207], v[232:235]
    ds_read_b64_tr_b16 v[72:73], v25 offset:53248
    ds_read_b64_tr_b16 v[74:75], v25 offset:53760
    v_mfma_f32_16x16x32_bf16 v[236:239], v[84:87], v[208:211], v[236:239]
    ds_read_b64_tr_b16 v[76:77], v26 offset:53248
    ds_read_b64_tr_b16 v[78:79], v26 offset:53760
    v_mfma_f32_16x16x32_bf16 v[240:243], v[88:91], v[208:211], v[240:243]
    ds_read_b64_tr_b16 v[80:81], v27 offset:53248
    ds_read_b64_tr_b16 v[82:83], v27 offset:53760
    v_mfma_f32_16x16x32_bf16 v[244:247], v[92:95], v[208:211], v[244:247]
    v_mfma_f32_16x16x32_bf16 v[248:251], v[96:99], v[208:211], v[248:251]
    s_waitcnt vmcnt(6)
    v_mfma_f32_16x16x32_bf16 v[220:223], v[100:103], v[212:215], v[220:223]
    s_add_u32 s7, s43, 8192
    buffer_load_dwordx4 v[204:207], v33, s[20:23], s7 offen offset:2048 sc1
    v_mfma_f32_16x16x32_bf16 v[224:227], v[104:107], v[212:215], v[224:227]
    s_add_u32 s7, s43, 8192
    buffer_load_dwordx4 v[208:211], v33, s[20:23], s7 offen offset:3072 sc1
    v_mfma_f32_16x16x32_bf16 v[228:231], v[108:111], v[212:215], v[228:231]
    ds_read_b64_tr_b16 v[84:85], v24 offset:57344
    ds_read_b64_tr_b16 v[86:87], v24 offset:57856
    v_mfma_f32_16x16x32_bf16 v[232:235], v[112:115], v[212:215], v[232:235]
    ds_read_b64_tr_b16 v[88:89], v25 offset:57344
    ds_read_b64_tr_b16 v[90:91], v25 offset:57856
    v_mfma_f32_16x16x32_bf16 v[236:239], v[100:103], v[216:219], v[236:239]
    ds_read_b64_tr_b16 v[92:93], v26 offset:57344
    ds_read_b64_tr_b16 v[94:95], v26 offset:57856
    v_mfma_f32_16x16x32_bf16 v[240:243], v[104:107], v[216:219], v[240:243]
    ds_read_b64_tr_b16 v[96:97], v27 offset:57344
    ds_read_b64_tr_b16 v[98:99], v27 offset:57856
    v_mfma_f32_16x16x32_bf16 v[244:247], v[108:111], v[216:219], v[244:247]
    v_mfma_f32_16x16x32_bf16 v[248:251], v[112:115], v[216:219], v[248:251]
    s_waitcnt vmcnt(6)
    v_mfma_f32_16x16x32_bf16 v[220:223], v[116:119], v[180:183], v[220:223]
    s_add_u32 s7, s43, 12288
    buffer_load_dwordx4 v[212:215], v33, s[20:23], s7 offen offset:0 sc1
    v_mfma_f32_16x16x32_bf16 v[224:227], v[120:123], v[180:183], v[224:227]
    s_add_u32 s7, s43, 12288
    buffer_load_dwordx4 v[216:219], v33, s[20:23], s7 offen offset:1024 sc1
    v_mfma_f32_16x16x32_bf16 v[228:231], v[124:127], v[180:183], v[228:231]
    ds_read_b64_tr_b16 v[100:101], v24 offset:61440
    ds_read_b64_tr_b16 v[102:103], v24 offset:61952
    v_mfma_f32_16x16x32_bf16 v[232:235], v[128:131], v[180:183], v[232:235]
    ds_read_b64_tr_b16 v[104:105], v25 offset:61440
    ds_read_b64_tr_b16 v[106:107], v25 offset:61952
    v_mfma_f32_16x16x32_bf16 v[236:239], v[116:119], v[184:187], v[236:239]
    ds_read_b64_tr_b16 v[108:109], v26 offset:61440
    ds_read_b64_tr_b16 v[110:111], v26 offset:61952
    v_mfma_f32_16x16x32_bf16 v[240:243], v[120:123], v[184:187], v[240:243]
    ds_read_b64_tr_b16 v[112:113], v27 offset:61440
    ds_read_b64_tr_b16 v[114:115], v27 offset:61952
    v_mfma_f32_16x16x32_bf16 v[244:247], v[124:127], v[184:187], v[244:247]
    v_mfma_f32_16x16x32_bf16 v[248:251], v[128:131], v[184:187], v[248:251]
    s_waitcnt vmcnt(6)
    v_mfma_f32_16x16x32_bf16 v[220:223], v[132:135], v[188:191], v[220:223]
    s_add_u32 s7, s43, 12288
    buffer_load_dwordx4 v[180:183], v33, s[20:23], s7 offen offset:2048 sc1
    v_mfma_f32_16x16x32_bf16 v[224:227], v[136:139], v[188:191], v[224:227]
    s_add_u32 s7, s43, 12288
    buffer_load_dwordx4 v[184:187], v33, s[20:23], s7 offen offset:3072 sc1
    v_mfma_f32_16x16x32_bf16 v[228:231], v[140:143], v[188:191], v[228:231]
    ds_read_b64_tr_b16 v[116:117], v24 offset:24576
    ds_read_b64_tr_b16 v[118:119], v24 offset:25088
    v_mfma_f32_16x16x32_bf16 v[232:235], v[144:147], v[188:191], v[232:235]
    ds_read_b64_tr_b16 v[120:121], v25 offset:24576
    ds_read_b64_tr_b16 v[122:123], v25 offset:25088
    v_mfma_f32_16x16x32_bf16 v[236:239], v[132:135], v[192:195], v[236:239]
    ds_read_b64_tr_b16 v[124:125], v26 offset:24576
    ds_read_b64_tr_b16 v[126:127], v26 offset:25088
    v_mfma_f32_16x16x32_bf16 v[240:243], v[136:139], v[192:195], v[240:243]
    ds_read_b64_tr_b16 v[128:129], v27 offset:24576
    ds_read_b64_tr_b16 v[130:131], v27 offset:25088
    v_mfma_f32_16x16x32_bf16 v[244:247], v[140:143], v[192:195], v[244:247]
    v_mfma_f32_16x16x32_bf16 v[248:251], v[144:147], v[192:195], v[248:251]
    s_waitcnt vmcnt(6)
    v_mfma_f32_16x16x32_bf16 v[220:223], v[148:151], v[196:199], v[220:223]
    s_add_u32 s7, s43, 4096
    buffer_load_dwordx4 v[188:191], v33, s[20:23], s7 offen offset:2048 sc1
    v_mfma_f32_16x16x32_bf16 v[224:227], v[152:155], v[196:199], v[224:227]
    s_add_u32 s7, s43, 4096
    buffer_load_dwordx4 v[192:195], v33, s[20:23], s7 offen offset:3072 sc1
    v_mfma_f32_16x16x32_bf16 v[228:231], v[156:159], v[196:199], v[228:231]
    ds_read_b64_tr_b16 v[132:133], v24 offset:28672
    ds_read_b64_tr_b16 v[134:135], v24 offset:29184
    v_mfma_f32_16x16x32_bf16 v[232:235], v[160:163], v[196:199], v[232:235]
    ds_read_b64_tr_b16 v[136:137], v25 offset:28672
    ds_read_b64_tr_b16 v[138:139], v25 offset:29184
    v_mfma_f32_16x16x32_bf16 v[236:239], v[148:151], v[200:203], v[236:239]
    ds_read_b64_tr_b16 v[140:141], v26 offset:28672
    ds_read_b64_tr_b16 v[142:143], v26 offset:29184
    v_mfma_f32_16x16x32_bf16 v[240:243], v[152:155], v[200:203], v[240:243]
    ds_read_b64_tr_b16 v[144:145], v27 offset:28672
    ds_read_b64_tr_b16 v[146:147], v27 offset:29184
    v_mfma_f32_16x16x32_bf16 v[244:247], v[156:159], v[200:203], v[244:247]
    v_mfma_f32_16x16x32_bf16 v[248:251], v[160:163], v[200:203], v[248:251]
    s_waitcnt vmcnt(7)
    v_mfma_f32_16x16x32_bf16 v[220:223], v[164:167], v[204:207], v[220:223]
    v_mfma_f32_16x16x32_bf16 v[224:227], v[168:171], v[204:207], v[224:227]
    v_mfma_f32_16x16x32_bf16 v[228:231], v[172:175], v[204:207], v[228:231]
    v_mfma_f32_16x16x32_bf16 v[232:235], v[176:179], v[204:207], v[232:235]
    s_waitcnt vmcnt(6) lgkmcnt(14)
    v_mfma_f32_16x16x32_bf16 v[220:223], v[36:39], v[208:211], v[220:223]
    ds_write_b128 v28, v[236:239] offset:0
    v_mfma_f32_16x16x32_bf16 v[224:227], v[40:43], v[208:211], v[224:227]
    ds_write_b128 v28, v[240:243] offset:1024
    v_mfma_f32_16x16x32_bf16 v[228:231], v[44:47], v[208:211], v[228:231]
    v_mfma_f32_16x16x32_bf16 v[232:235], v[48:51], v[208:211], v[232:235]
    s_waitcnt vmcnt(5) lgkmcnt(14)
    v_mfma_f32_16x16x32_bf16 v[220:223], v[52:55], v[212:215], v[220:223]
    ds_write_b128 v28, v[244:247] offset:2048
    v_mfma_f32_16x16x32_bf16 v[224:227], v[56:59], v[212:215], v[224:227]
    ds_write_b128 v28, v[248:251] offset:3072
    v_mfma_f32_16x16x32_bf16 v[228:231], v[60:63], v[212:215], v[228:231]
    v_mfma_f32_16x16x32_bf16 v[232:235], v[64:67], v[212:215], v[232:235]
    s_waitcnt vmcnt(4) lgkmcnt(0)
    ds_write_b32 v29, v18 offset:16
    v_mfma_f32_16x16x32_bf16 v[220:223], v[68:71], v[216:219], v[220:223]
    v_mfma_f32_16x16x32_bf16 v[224:227], v[72:75], v[216:219], v[224:227]
    v_mfma_f32_16x16x32_bf16 v[228:231], v[76:79], v[216:219], v[228:231]
    v_mfma_f32_16x16x32_bf16 v[232:235], v[80:83], v[216:219], v[232:235]
    s_waitcnt vmcnt(3) lgkmcnt(14)
    v_mfma_f32_16x16x32_bf16 v[220:223], v[84:87], v[180:183], v[220:223]
    v_mfma_f32_16x16x32_bf16 v[224:227], v[88:91], v[180:183], v[224:227]
    v_mfma_f32_16x16x32_bf16 v[228:231], v[92:95], v[180:183], v[228:231]
    v_mfma_f32_16x16x32_bf16 v[232:235], v[96:99], v[180:183], v[232:235]
    s_waitcnt vmcnt(2) lgkmcnt(14)
    v_mfma_f32_16x16x32_bf16 v[220:223], v[100:103], v[184:187], v[220:223]
    v_mfma_f32_16x16x32_bf16 v[224:227], v[104:107], v[184:187], v[224:227]
    v_mfma_f32_16x16x32_bf16 v[228:231], v[108:111], v[184:187], v[228:231]
    v_mfma_f32_16x16x32_bf16 v[232:235], v[112:115], v[184:187], v[232:235]
    s_waitcnt vmcnt(1) lgkmcnt(13)
    v_mfma_f32_16x16x32_bf16 v[220:223], v[116:119], v[188:191], v[220:223]
    v_mfma_f32_16x16x32_bf16 v[224:227], v[120:123], v[188:191], v[224:227]
    v_mfma_f32_16x16x32_bf16 v[228:231], v[124:127], v[188:191], v[228:231]
    v_mfma_f32_16x16x32_bf16 v[232:235], v[128:131], v[188:191], v[232:235]
    s_waitcnt vmcnt(0) lgkmcnt(5)
    v_mfma_f32_16x16x32_bf16 v[220:223], v[132:135], v[192:195], v[220:223]
    v_mfma_f32_16x16x32_bf16 v[224:227], v[136:139], v[192:195], v[224:227]
    v_mfma_f32_16x16x32_bf16 v[228:231], v[140:143], v[192:195], v[228:231]
    v_mfma_f32_16x16x32_bf16 v[232:235], v[144:147], v[192:195], v[232:235]
    s_nop 7
    v_cvt_pk_bf16_f32 v36, v220, v221
    v_cvt_pk_bf16_f32 v37, v222, v223
    ds_write_b64 v30, v[36:37] offset:0
    v_cvt_pk_bf16_f32 v38, v224, v225
    v_cvt_pk_bf16_f32 v39, v226, v227
    ds_write_b64 v30, v[38:39] offset:32
    v_cvt_pk_bf16_f32 v40, v228, v229
    v_cvt_pk_bf16_f32 v41, v230, v231
    ds_write_b64 v30, v[40:41] offset:64
    v_cvt_pk_bf16_f32 v42, v232, v233
    v_cvt_pk_bf16_f32 v43, v234, v235
    ds_write_b64 v30, v[42:43] offset:96
    ds_read_b128 v[52:55], v31 offset:0
    ds_read_b128 v[56:59], v31 offset:1152
    s_waitcnt lgkmcnt(1)
    buffer_store_dwordx4 v[52:55], v32, s[44:47], s48 offen sc1
    s_waitcnt lgkmcnt(0)
    buffer_store_dwordx4 v[56:59], v32, s[44:47], s49 offen sc1
    s_cmp_lg_u32 s99, 0
    s_cbranch_scc1 K_A_NOBO
    s_barrier
K_A_NOBO:
    s_endpgm
.fill 6, 4, 0xbf800000
K_A_CONS:
    v_mov_b32 v33, s96
    v_mov_b32 v34, 1
    v_mov_b32 v35, 0x80000000
    v_cmp_ne_u32 vcc, 256, v0
    s_nop 1
    v_cndmask_b32 v35, 0, v35, vcc
    s_lshl_b32 s58, s59, 3
    s_add_u32 s58, s58, s29
    s_lshl_b32 s58, s58, 7
    s_lshl_b32 s6, s29, 2
    s_add_u32 s6, s6, s3
    s_mul_i32 s6, s6, 3
    s_add_u32 s6, s6, s32
    s_lshl_b32 s6, s6, 1
    s_add_u32 s6, s6, s30
    s_lshl_b32 s60, s6, 10
    v_lshlrev_b32 v7, 4, v2
    s_waitcnt lgkmcnt(0)
    s_add_u32 s16, s56, 0x500000
    s_addc_u32 s17, s57, 0
    s_mov_b32 s18, 0x10000
    s_mov_b32 s19, 0x20000
    s_add_u32 s8, s56, 0x0
    s_addc_u32 s9, s57, 0
    s_mov_b32 s10, 0x240000
    s_mov_b32 s11, 0x20000
    s_mov_b32 s20, s54
    s_mov_b32 s21, s55
    s_mov_b32 s22, 0x100
    s_mov_b32 s23, 0x20000
    s_cmp_lg_u32 s5, 0
    s_cbranch_scc1 K_A_NOCLR
    v_mov_b32 v8, 0
    v_mov_b32 v9, 0
    v_mov_b32 v10, 0
    v_mov_b32 v11, 0
    v_lshlrev_b32 v7, 4, v2
    s_lshl_b32 s6, s4, 2
    s_add_u32 s6, s6, s3
    s_lshl_b32 s6, s6, 11
    buffer_store_dwordx4 v[8:11], v7, s[16:19], s6 offen sc1
    buffer_store_dwordx4 v[8:11], v7, s[16:19], s6 offen offset:1024 sc1
    s_nop 1
K_A_NOCLR:
    s_lshl_b32 s35, s4, 2
    v_lshrrev_b32 v7, 1, v3
    v_xor_b32 v7, v7, v4
    v_lshlrev_b32 v7, 4, v7
    v_lshl_add_u32 v7, v3, 7, v7
    v_xor_b32 v8, 64, v7
    v_add_u32 v20, 0, v7
    v_add_u32_e64 v21, 0, v8
    v_add_u32 v22, 36864, v7
    v_add_u32 v23, 36864, v8
    v_add_u32 v24, 73728, v7
    v_add_u32 v25, 73728, v8
    v_add_u32 v26, 110592, v7
    v_add_u32 v27, 110592, v8
    v_bfe_u32 v7, v2, 2, 2
    v_lshrrev_b32 v8, 1, v7
    v_and_b32 v9, 1, v4
    v_lshl_or_b32 v8, v9, 1, v8
    v_xor_b32 v8, s3, v8
    v_lshlrev_b32 v8, 5, v8
    v_lshl_add_u32 v8, v7, 7, v8
    v_and_b32 v9, 3, v2
    v_lshl_add_u32 v8, v9, 3, v8
    v_mul_u32_u24 v9, 3072, v4
    v_add_u32 v8, v8, v9
    v_add_u32 v28, 12288, v8
    v_add_u32 v29, 49152, v8
    v_add_u32 v30, 86016, v8
    v_add_u32 v31, 122880, v8
    v_lshlrev_b32 v7, 2, v4
    v_sub_u32 v7, v3, v7
    v_mov_b32 v9, 0xf149f2ca
    v_mov_b32 v10, 0xffff
    v_mov_b32 v11, 0xffff0000
    v_subrev_u32 v8, 0, v7
    v_cmp_le_u32 vcc, 8, v8
    s_nop 1
    v_cndmask_b32 v36, 0, v9, vcc
    v_cmp_lt_i32 vcc, -9, v8
    s_nop 1
    v_cndmask_b32 v40, 0, v9, vcc
    v_cmp_le_i32 vcc, 0, v8
    s_nop 1
    v_cndmask_b32 v12, 0, v10, vcc
    v_subrev_u32 v8, 1, v7
    v_cmp_le_u32 vcc, 8, v8
    s_nop 1
    v_cndmask_b32 v37, 0, v9, vcc
    v_cmp_lt_i32 vcc, -9, v8
    s_nop 1
    v_cndmask_b32 v41, 0, v9, vcc
    v_cmp_le_i32 vcc, 0, v8
    s_nop 1
    v_cndmask_b32 v13, 0, v11, vcc
    v_subrev_u32 v8, 2, v7
    v_cmp_le_u32 vcc, 8, v8
    s_nop 1
    v_cndmask_b32 v38, 0, v9, vcc
    v_cmp_lt_i32 vcc, -9, v8
    s_nop 1
    v_cndmask_b32 v42, 0, v9, vcc
    v_cmp_le_i32 vcc, 0, v8
    s_nop 1
    v_cndmask_b32 v14, 0, v10, vcc
    v_subrev_u32 v8, 3, v7
    v_cmp_le_u32 vcc, 8, v8
    s_nop 1
    v_cndmask_b32 v39, 0, v9, vcc
    v_cmp_lt_i32 vcc, -9, v8
    s_nop 1
    v_cndmask_b32 v43, 0, v9, vcc
    v_cmp_le_i32 vcc, 0, v8
    s_nop 1
    v_cndmask_b32 v15, 0, v11, vcc
    v_or_b32 v44, v12, v13
    v_or_b32 v45, v14, v15
    v_mov_b32 v46, 0x3f803f80
    v_mov_b32 v47, 0x3f803f80
    s_lshl_b32 s6, s29, 2
    s_add_u32 s6, s6, s3
    s_lshl_b32 s6, s6, 9
    s_mul_i32 s7, s59, 98304
    s_add_u32 s60, s6, s7
    s_add_u32 s61, s60, 0x8000
    s_add_u32 s62, s60, 0x10000
    v_and_b32 v7, 1, v4
    v_lshlrev_b32 v7, 14, v7
    v_lshrrev_b32_e64 v8, 1, v4
    v_lshl_add_u32 v7, v8, 8, v7
    v_lshl_add_u32 v32, v3, 4, v7
    v_mov_b32 v17, 147456
    s_lshl_b32 s6, s3, 2
    v_mov_b32 v18, s6
    s_mov_b32 s34, 0x3eb8aa3b
    s_mov_b32 s24, s34
    s_mov_b32 s25, s34
    v_mov_b32 v120, 0
    v_mov_b32 v121, 0
    v_mov_b32 v122, 0
    v_mov_b32 v123, 0
    v_mov_b32 v124, 0
    v_mov_b32 v125, 0
    v_mov_b32 v126, 0
    v_mov_b32 v127, 0
    v_mov_b32 v128, 0
    v_mov_b32 v129, 0
    v_mov_b32 v130, 0
    v_mov_b32 v131, 0
    v_mov_b32 v132, 0
    v_mov_b32 v133, 0
    v_mov_b32 v134, 0
    v_mov_b32 v135, 0
    v_mov_b32 v136, 0
    v_mov_b32 v137, 0
    v_mov_b32 v138, 0
    v_mov_b32 v139, 0
    v_mov_b32 v140, 0
    v_mov_b32 v141, 0
    v_mov_b32 v142, 0
    v_mov_b32 v143, 0
    v_mov_b32 v144, 0
    v_mov_b32 v145, 0
    v_mov_b32 v146, 0
    v_mov_b32 v147, 0
    v_mov_b32 v148, 0
    v_mov_b32 v149, 0
    v_mov_b32 v150, 0
    v_mov_b32 v151, 0
    v_mov_b32 v152, 0
    v_mov_b32 v153, 0
    v_mov_b32 v154, 0
    v_mov_b32 v155, 0
    v_mov_b32 v156, 0
    v_mov_b32 v157, 0
    v_mov_b32 v158, 0
    v_mov_b32 v159, 0
    v_mov_b32 v160, 0
    v_mov_b32 v161, 0
    v_mov_b32 v162, 0
    v_mov_b32 v163, 0
    v_mov_b32 v164, 0
    v_mov_b32 v165, 0
    v_mov_b32 v166, 0
    v_mov_b32 v167, 0
    v_mov_b32 v168, 0
    v_mov_b32 v169, 0
    v_mov_b32 v170, 0
    v_mov_b32 v171, 0
    v_mov_b32 v172, 0
    v_mov_b32 v173, 0
    v_mov_b32 v174, 0
    v_mov_b32 v175, 0
    v_mov_b32 v176, 0
    v_mov_b32 v177, 0
    v_mov_b32 v178, 0
    v_mov_b32 v179, 0
    v_mov_b32 v180, 0
    v_mov_b32 v181, 0
    v_mov_b32 v182, 0
    v_mov_b32 v183, 0
    v_mov_b32 v184, 0
    v_mov_b32 v185, 0
    v_mov_b32 v186, 0
    v_mov_b32 v187, 0
    v_mov_b32 v188, 0
    v_mov_b32 v189, 0
    v_mov_b32 v190, 0
    v_mov_b32_e64 v191, 0
    s_mov_b32 s28, 0
    s_setprio 2
    s_barrier
    ds_read_b64_tr_b16 v[72:73], v28 offset:0
    ds_read_b64_tr_b16 v[74:75], v28 offset:512
    ds_read_b128 v[48:51], v20 offset:0
    ds_read_b128 v[52:55], v20 offset:2048
    ds_read_b128 v[56:59], v20 offset:4096
    ds_read_b128 v[60:63], v20 offset:6144
    ds_read_b128 v[64:67], v20 offset:8192
    ds_read_b128 v[68:71], v20 offset:10240
    ds_read_b64_tr_b16 v[76:77], v28 offset:1024
    ds_read_b64_tr_b16 v[78:79], v28 offset:1536
    ds_read_b64_tr_b16 v[80:81], v28 offset:2048
    ds_read_b64_tr_b16 v[82:83], v28 offset:2560
K_A_ML:
    s_waitcnt lgkmcnt(0)
    v_mfma_f32_16x16x32_bf16 v[120:123], v[72:75], v[48:51], v[120:123]
    ds_read_b64_tr_b16 v[108:109], v28 offset:12288
    v_mfma_f32_16x16x32_bf16 v[124:127], v[72:75], v[52:55], v[124:127]
    ds_read_b64_tr_b16 v[110:111], v28 offset:12800
    v_mfma_f32_16x16x32_bf16 v[128:131], v[72:75], v[56:59], v[128:131]
    ds_read_b128 v[84:87], v21 offset:0
    v_mfma_f32_16x16x32_bf16 v[132:135], v[72:75], v[60:63], v[132:135]
    ds_read_b128 v[88:91], v21 offset:2048
    v_mfma_f32_16x16x32_bf16 v[136:139], v[72:75], v[64:67], v[136:139]
    ds_read_b128 v[92:95], v21 offset:4096
    v_mfma_f32_16x16x32_bf16 v[140:143], v[72:75], v[68:71], v[140:143]
    ds_read_b128 v[96:99], v21 offset:6144
    v_mfma_f32_16x16x32_bf16 v[144:147], v[76:79], v[48:51], v[144:147]
    ds_read_b128 v[100:103], v21 offset:8192
    v_mfma_f32_16x16x32_bf16 v[148:151], v[76:79], v[52:55], v[148:151]
    ds_read_b128 v[104:107], v21 offset:10240
    v_mfma_f32_16x16x32_bf16 v[152:155], v[76:79], v[56:59], v[152:155]
    ds_read_b64_tr_b16 v[112:113], v28 offset:13312
    v_mfma_f32_16x16x32_bf16 v[156:159], v[76:79], v[60:63], v[156:159]
    ds_read_b64_tr_b16 v[114:115], v28 offset:13824
    v_mfma_f32_16x16x32_bf16 v[160:163], v[76:79], v[64:67], v[160:163]
    ds_read_b64_tr_b16 v[116:117], v28 offset:14336
    v_mfma_f32_16x16x32_bf16 v[164:167], v[76:79], v[68:71], v[164:167]
    ds_read_b64_tr_b16 v[118:119], v28 offset:14848
    v_mfma_f32_16x16x32_bf16 v[168:171], v[48:51], v[80:83], v[168:171]
    v_mfma_f32_16x16x32_bf16 v[172:175], v[52:55], v[80:83], v[172:175]
    v_mfma_f32_16x16x32_bf16 v[176:179], v[56:59], v[80:83], v[176:179]
    v_mfma_f32_16x16x32_bf16 v[180:183], v[60:63], v[80:83], v[180:183]
    v_mfma_f32_16x16x32_bf16 v[184:187], v[64:67], v[80:83], v[184:187]
    v_mfma_f32_16x16x32_bf16 v[188:191], v[68:71], v[80:83], v[188:191]
    s_waitcnt lgkmcnt(0)
    v_mfma_f32_16x16x32_bf16 v[120:123], v[108:111], v[84:87], v[120:123]
    v_mfma_f32_16x16x32_bf16 v[124:127], v[108:111], v[88:91], v[124:127]
    v_mfma_f32_16x16x32_bf16 v[128:131], v[108:111], v[92:95], v[128:131]
    v_mfma_f32_16x16x32_bf16 v[132:135], v[108:111], v[96:99], v[132:135]
    v_mfma_f32_16x16x32_bf16 v[136:139], v[108:111], v[100:103], v[136:139]
    v_mfma_f32_16x16x32_bf16 v[140:143], v[108:111], v[104:107], v[140:143]
    v_mfma_f32_16x16x32_bf16 v[144:147], v[112:115], v[84:87], v[144:147]
    v_mfma_f32_16x16x32_bf16 v[148:151], v[112:115], v[88:91], v[148:151]
    v_mfma_f32_16x16x32_bf16 v[152:155], v[112:115], v[92:95], v[152:155]
    v_mfma_f32_16x16x32_bf16 v[156:159], v[112:115], v[96:99], v[156:159]
    v_mfma_f32_16x16x32_bf16 v[160:163], v[112:115], v[100:103], v[160:163]
    v_mfma_f32_16x16x32_bf16 v[164:167], v[112:115], v[104:107], v[164:167]
    s_barrier
    v_mfma_f32_16x16x32_bf16 v[168:171], v[84:87], v[116:119], v[168:171]
    ds_read_b64_tr_b16 v[72:73], v29 offset:0
    ds_read_b64_tr_b16 v[74:75], v29 offset:512
    v_mfma_f32_16x16x32_bf16 v[172:175], v[88:91], v[116:119], v[172:175]
    ds_read_b128 v[48:51], v22 offset:0
    ds_read_b128 v[52:55], v22 offset:2048
    v_mfma_f32_16x16x32_bf16 v[176:179], v[92:95], v[116:119], v[176:179]
    ds_read_b128 v[56:59], v22 offset:4096
    ds_read_b128 v[60:63], v22 offset:6144
    v_mfma_f32_16x16x32_bf16 v[180:183], v[96:99], v[116:119], v[180:183]
    ds_read_b128 v[64:67], v22 offset:8192
    ds_read_b128 v[68:71], v22 offset:10240
    v_mfma_f32_16x16x32_bf16 v[184:187], v[100:103], v[116:119], v[184:187]
    ds_read_b64_tr_b16 v[76:77], v29 offset:1024
    ds_read_b64_tr_b16 v[78:79], v29 offset:1536
    v_mfma_f32_16x16x32_bf16 v[188:191], v[104:107], v[116:119], v[188:191]
    ds_read_b64_tr_b16 v[80:81], v29 offset:2048
    ds_read_b64_tr_b16 v[82:83], v29 offset:2560
    s_waitcnt lgkmcnt(0)
    v_mfma_f32_16x16x32_bf16 v[120:123], v[72:75], v[48:51], v[120:123]
    ds_read_b64_tr_b16 v[108:109], v29 offset:12288
    v_mfma_f32_16x16x32_bf16 v[124:127], v[72:75], v[52:55], v[124:127]
    ds_read_b64_tr_b16 v[110:111], v29 offset:12800
    v_mfma_f32_16x16x32_bf16 v[128:131], v[72:75], v[56:59], v[128:131]
    ds_read_b128 v[84:87], v23 offset:0
    v_mfma_f32_16x16x32_bf16 v[132:135], v[72:75], v[60:63], v[132:135]
    ds_read_b128 v[88:91], v23 offset:2048
    v_mfma_f32_16x16x32_bf16 v[136:139], v[72:75], v[64:67], v[136:139]
    ds_read_b128 v[92:95], v23 offset:4096
    v_mfma_f32_16x16x32_bf16 v[140:143], v[72:75], v[68:71], v[140:143]
    ds_read_b128 v[96:99], v23 offset:6144
    v_mfma_f32_16x16x32_bf16 v[144:147], v[76:79], v[48:51], v[144:147]
    ds_read_b128 v[100:103], v23 offset:8192
    v_mfma_f32_16x16x32_bf16 v[148:151], v[76:79], v[52:55], v[148:151]
    ds_read_b128 v[104:107], v23 offset:10240
    v_mfma_f32_16x16x32_bf16 v[152:155], v[76:79], v[56:59], v[152:155]
    ds_read_b64_tr_b16 v[112:113], v29 offset:13312
    v_mfma_f32_16x16x32_bf16 v[156:159], v[76:79], v[60:63], v[156:159]
    ds_read_b64_tr_b16 v[114:115], v29 offset:13824
    v_mfma_f32_16x16x32_bf16 v[160:163], v[76:79], v[64:67], v[160:163]
    ds_read_b64_tr_b16 v[116:117], v29 offset:14336
    v_mfma_f32_16x16x32_bf16 v[164:167], v[76:79], v[68:71], v[164:167]
    ds_read_b64_tr_b16 v[118:119], v29 offset:14848
    v_mfma_f32_16x16x32_bf16 v[168:171], v[48:51], v[80:83], v[168:171]
    s_waitcnt vmcnt(0)
    v_mfma_f32_16x16x32_bf16 v[172:175], v[52:55], v[80:83], v[172:175]
    v_mfma_f32_16x16x32_bf16 v[176:179], v[56:59], v[80:83], v[176:179]
    v_mfma_f32_16x16x32_bf16 v[180:183], v[60:63], v[80:83], v[180:183]
    v_mfma_f32_16x16x32_bf16 v[184:187], v[64:67], v[80:83], v[184:187]
    v_mfma_f32_16x16x32_bf16 v[188:191], v[68:71], v[80:83], v[188:191]
    s_waitcnt lgkmcnt(0)
    v_mfma_f32_16x16x32_bf16 v[120:123], v[108:111], v[84:87], v[120:123]
    v_mfma_f32_16x16x32_bf16 v[124:127], v[108:111], v[88:91], v[124:127]
    v_mfma_f32_16x16x32_bf16 v[128:131], v[108:111], v[92:95], v[128:131]
    v_mfma_f32_16x16x32_bf16 v[132:135], v[108:111], v[96:99], v[132:135]
    v_mfma_f32_16x16x32_bf16 v[136:139], v[108:111], v[100:103], v[136:139]
    v_mfma_f32_16x16x32_bf16 v[140:143], v[108:111], v[104:107], v[140:143]
    v_mfma_f32_16x16x32_bf16 v[144:147], v[112:115], v[84:87], v[144:147]
    v_mfma_f32_16x16x32_bf16 v[148:151], v[112:115], v[88:91], v[148:151]
    v_mfma_f32_16x16x32_bf16 v[152:155], v[112:115], v[92:95], v[152:155]
    v_mfma_f32_16x16x32_bf16 v[156:159], v[112:115], v[96:99], v[156:159]
    v_mfma_f32_16x16x32_bf16 v[160:163], v[112:115], v[100:103], v[160:163]
    v_mfma_f32_16x16x32_bf16 v[164:167], v[112:115], v[104:107], v[164:167]
    s_barrier
    v_mfma_f32_16x16x32_bf16 v[168:171], v[84:87], v[116:119], v[168:171]
    ds_read_b64_tr_b16 v[72:73], v30 offset:0
    ds_read_b64_tr_b16 v[74:75], v30 offset:512
    v_mfma_f32_16x16x32_bf16 v[172:175], v[88:91], v[116:119], v[172:175]
    ds_read_b128 v[48:51], v24 offset:0
    ds_read_b128 v[52:55], v24 offset:2048
    v_mfma_f32_16x16x32_bf16 v[176:179], v[92:95], v[116:119], v[176:179]
    ds_read_b128 v[56:59], v24 offset:4096
    ds_read_b128 v[60:63], v24 offset:6144
    v_mfma_f32_16x16x32_bf16 v[180:183], v[96:99], v[116:119], v[180:183]
    ds_read_b128 v[64:67], v24 offset:8192
    ds_read_b128 v[68:71], v24 offset:10240
    v_mfma_f32_16x16x32_bf16 v[184:187], v[100:103], v[116:119], v[184:187]
    ds_read_b64_tr_b16 v[76:77], v30 offset:1024
    ds_read_b64_tr_b16 v[78:79], v30 offset:1536
    v_mfma_f32_16x16x32_bf16 v[188:191], v[104:107], v[116:119], v[188:191]
    ds_read_b64_tr_b16 v[80:81], v30 offset:2048
    ds_read_b64_tr_b16 v[82:83], v30 offset:2560
    s_waitcnt lgkmcnt(0)
    v_mfma_f32_16x16x32_bf16 v[120:123], v[72:75], v[48:51], v[120:123]
    ds_read_b64_tr_b16 v[108:109], v30 offset:12288
    v_mfma_f32_16x16x32_bf16 v[124:127], v[72:75], v[52:55], v[124:127]
    ds_read_b64_tr_b16 v[110:111], v30 offset:12800
    v_mfma_f32_16x16x32_bf16 v[128:131], v[72:75], v[56:59], v[128:131]
    ds_read_b128 v[84:87], v25 offset:0
    v_mfma_f32_16x16x32_bf16 v[132:135], v[72:75], v[60:63], v[132:135]
    ds_read_b128 v[88:91], v25 offset:2048
    v_mfma_f32_16x16x32_bf16 v[136:139], v[72:75], v[64:67], v[136:139]
    ds_read_b128 v[92:95], v25 offset:4096
    v_mfma_f32_16x16x32_bf16 v[140:143], v[72:75], v[68:71], v[140:143]
    ds_read_b128 v[96:99], v25 offset:6144
    v_mfma_f32_16x16x32_bf16 v[144:147], v[76:79], v[48:51], v[144:147]
    ds_read_b128 v[100:103], v25 offset:8192
    v_mfma_f32_16x16x32_bf16 v[148:151], v[76:79], v[52:55], v[148:151]
    ds_read_b128 v[104:107], v25 offset:10240
    v_mfma_f32_16x16x32_bf16 v[152:155], v[76:79], v[56:59], v[152:155]
    ds_read_b64_tr_b16 v[112:113], v30 offset:13312
    v_mfma_f32_16x16x32_bf16 v[156:159], v[76:79], v[60:63], v[156:159]
    ds_read_b64_tr_b16 v[114:115], v30 offset:13824
    v_mfma_f32_16x16x32_bf16 v[160:163], v[76:79], v[64:67], v[160:163]
    ds_read_b64_tr_b16 v[116:117], v30 offset:14336
    v_mfma_f32_16x16x32_bf16 v[164:167], v[76:79], v[68:71], v[164:167]
    ds_read_b64_tr_b16 v[118:119], v30 offset:14848
    v_mfma_f32_16x16x32_bf16 v[168:171], v[48:51], v[80:83], v[168:171]
    s_or_b32 s6, s5, s28
    s_cmp_lg_u32 s6, 0
    s_cbranch_scc1 K_A_NOGO
    buffer_store_dword v34, v35, s[20:23], s35 offen sc1
K_A_NOGO:
    v_mfma_f32_16x16x32_bf16 v[172:175], v[52:55], v[80:83], v[172:175]
    v_mfma_f32_16x16x32_bf16 v[176:179], v[56:59], v[80:83], v[176:179]
    v_mfma_f32_16x16x32_bf16 v[180:183], v[60:63], v[80:83], v[180:183]
    v_mfma_f32_16x16x32_bf16 v[184:187], v[64:67], v[80:83], v[184:187]
    v_mfma_f32_16x16x32_bf16 v[188:191], v[68:71], v[80:83], v[188:191]
    s_waitcnt lgkmcnt(0)
    v_mfma_f32_16x16x32_bf16 v[120:123], v[108:111], v[84:87], v[120:123]
    v_mfma_f32_16x16x32_bf16 v[124:127], v[108:111], v[88:91], v[124:127]
    v_mfma_f32_16x16x32_bf16 v[128:131], v[108:111], v[92:95], v[128:131]
    v_mfma_f32_16x16x32_bf16 v[132:135], v[108:111], v[96:99], v[132:135]
    v_mfma_f32_16x16x32_bf16 v[136:139], v[108:111], v[100:103], v[136:139]
    v_mfma_f32_16x16x32_bf16 v[140:143], v[108:111], v[104:107], v[140:143]
    v_mfma_f32_16x16x32_bf16 v[144:147], v[112:115], v[84:87], v[144:147]
    v_mfma_f32_16x16x32_bf16 v[148:151], v[112:115], v[88:91], v[148:151]
    v_mfma_f32_16x16x32_bf16 v[152:155], v[112:115], v[92:95], v[152:155]
    v_mfma_f32_16x16x32_bf16 v[156:159], v[112:115], v[96:99], v[156:159]
    v_mfma_f32_16x16x32_bf16 v[160:163], v[112:115], v[100:103], v[160:163]
    v_mfma_f32_16x16x32_bf16 v[164:167], v[112:115], v[104:107], v[164:167]
    s_barrier
    v_mfma_f32_16x16x32_bf16 v[168:171], v[84:87], v[116:119], v[168:171]
    ds_read_b64_tr_b16 v[72:73], v31 offset:0
    ds_read_b64_tr_b16 v[74:75], v31 offset:512
    v_mfma_f32_16x16x32_bf16 v[172:175], v[88:91], v[116:119], v[172:175]
    ds_read_b128 v[48:51], v26 offset:0
    ds_read_b128 v[52:55], v26 offset:2048
    v_mfma_f32_16x16x32_bf16 v[176:179], v[92:95], v[116:119], v[176:179]
    ds_read_b128 v[56:59], v26 offset:4096
    ds_read_b128 v[60:63], v26 offset:6144
    v_mfma_f32_16x16x32_bf16 v[180:183], v[96:99], v[116:119], v[180:183]
    ds_read_b128 v[64:67], v26 offset:8192
    ds_read_b128 v[68:71], v26 offset:10240
    v_mfma_f32_16x16x32_bf16 v[184:187], v[100:103], v[116:119], v[184:187]
    ds_read_b64_tr_b16 v[76:77], v31 offset:1024
    ds_read_b64_tr_b16 v[78:79], v31 offset:1536
    v_mfma_f32_16x16x32_bf16 v[188:191], v[104:107], v[116:119], v[188:191]
    ds_read_b64_tr_b16 v[80:81], v31 offset:2048
    ds_read_b64_tr_b16 v[82:83], v31 offset:2560
    s_cmp_lg_u32 s28, 0
    s_cbranch_scc1 K_A_MT
    s_waitcnt lgkmcnt(0)
    v_mfma_f32_16x16x32_bf16 v[120:123], v[72:75], v[48:51], v[120:123]
    ds_read_b64_tr_b16 v[108:109], v31 offset:12288
    v_mfma_f32_16x16x32_bf16 v[124:127], v[72:75], v[52:55], v[124:127]
    ds_read_b64_tr_b16 v[110:111], v31 offset:12800
    v_mfma_f32_16x16x32_bf16 v[128:131], v[72:75], v[56:59], v[128:131]
    ds_read_b128 v[84:87], v27 offset:0
    v_mfma_f32_16x16x32_bf16 v[132:135], v[72:75], v[60:63], v[132:135]
    ds_read_b128 v[88:91], v27 offset:2048
    v_mfma_f32_16x16x32_bf16 v[136:139], v[72:75], v[64:67], v[136:139]
    ds_read_b128 v[92:95], v27 offset:4096
    v_mfma_f32_16x16x32_bf16 v[140:143], v[72:75], v[68:71], v[140:143]
    ds_read_b128 v[96:99], v27 offset:6144
    v_mfma_f32_16x16x32_bf16 v[144:147], v[76:79], v[48:51], v[144:147]
    ds_read_b128 v[100:103], v27 offset:8192
    v_mfma_f32_16x16x32_bf16 v[148:151], v[76:79], v[52:55], v[148:151]
    ds_read_b128 v[104:107], v27 offset:10240
    v_mfma_f32_16x16x32_bf16 v[152:155], v[76:79], v[56:59], v[152:155]
    ds_read_b64_tr_b16 v[112:113], v31 offset:13312
    v_mfma_f32_16x16x32_bf16 v[156:159], v[76:79], v[60:63], v[156:159]
    ds_read_b64_tr_b16 v[114:115], v31 offset:13824
    v_mfma_f32_16x16x32_bf16 v[160:163], v[76:79], v[64:67], v[160:163]
    ds_read_b64_tr_b16 v[116:117], v31 offset:14336
    v_mfma_f32_16x16x32_bf16 v[164:167], v[76:79], v[68:71], v[164:167]
    ds_read_b64_tr_b16 v[118:119], v31 offset:14848
    v_mfma_f32_16x16x32_bf16 v[168:171], v[48:51], v[80:83], v[168:171]
    v_mfma_f32_16x16x32_bf16 v[172:175], v[52:55], v[80:83], v[172:175]
    v_mfma_f32_16x16x32_bf16 v[176:179], v[56:59], v[80:83], v[176:179]
    v_mfma_f32_16x16x32_bf16 v[180:183], v[60:63], v[80:83], v[180:183]
    v_mfma_f32_16x16x32_bf16 v[184:187], v[64:67], v[80:83], v[184:187]
    v_mfma_f32_16x16x32_bf16 v[188:191], v[68:71], v[80:83], v[188:191]
    s_waitcnt lgkmcnt(0)
    v_mfma_f32_16x16x32_bf16 v[120:123], v[108:111], v[84:87], v[120:123]
    v_mfma_f32_16x16x32_bf16 v[124:127], v[108:111], v[88:91], v[124:127]
    v_mfma_f32_16x16x32_bf16 v[128:131], v[108:111], v[92:95], v[128:131]
    v_mfma_f32_16x16x32_bf16 v[132:135], v[108:111], v[96:99], v[132:135]
    v_mfma_f32_16x16x32_bf16 v[136:139], v[108:111], v[100:103], v[136:139]
    v_mfma_f32_16x16x32_bf16 v[140:143], v[108:111], v[104:107], v[140:143]
    v_mfma_f32_16x16x32_bf16 v[144:147], v[112:115], v[84:87], v[144:147]
    v_mfma_f32_16x16x32_bf16 v[148:151], v[112:115], v[88:91], v[148:151]
    v_mfma_f32_16x16x32_bf16 v[152:155], v[112:115], v[92:95], v[152:155]
    v_mfma_f32_16x16x32_bf16 v[156:159], v[112:115], v[96:99], v[156:159]
    v_mfma_f32_16x16x32_bf16 v[160:163], v[112:115], v[100:103], v[160:163]
    v_mfma_f32_16x16x32_bf16 v[164:167], v[112:115], v[104:107], v[164:167]
    s_barrier
    v_mfma_f32_16x16x32_bf16 v[168:171], v[84:87], v[116:119], v[168:171]
    ds_read_b64_tr_b16 v[72:73], v28 offset:0
    ds_read_b64_tr_b16 v[74:75], v28 offset:512
    v_mfma_f32_16x16x32_bf16 v[172:175], v[88:91], v[116:119], v[172:175]
    ds_read_b128 v[48:51], v20 offset:0
    ds_read_b128 v[52:55], v20 offset:2048
    v_mfma_f32_16x16x32_bf16 v[176:179], v[92:95], v[116:119], v[176:179]
    ds_read_b128 v[56:59], v20 offset:4096
    ds_read_b128 v[60:63], v20 offset:6144
    v_mfma_f32_16x16x32_bf16 v[180:183], v[96:99], v[116:119], v[180:183]
    ds_read_b128 v[64:67], v20 offset:8192
    ds_read_b128 v[68:71], v20 offset:10240
    v_mfma_f32_16x16x32_bf16 v[184:187], v[100:103], v[116:119], v[184:187]
    ds_read_b64_tr_b16 v[76:77], v28 offset:1024
    ds_read_b64_tr_b16 v[78:79], v28 offset:1536
    v_mfma_f32_16x16x32_bf16 v[188:191], v[104:107], v[116:119], v[188:191]
    ds_read_b64_tr_b16 v[80:81], v28 offset:2048
    ds_read_b64_tr_b16 v[82:83], v28 offset:2560
    s_mov_b32 s28, 1
    s_branch K_A_ML
K_A_MT:
    s_waitcnt lgkmcnt(0)
    v_mfma_f32_16x16x32_bf16 v[120:123], v[72:75], v[48:51], v[120:123]
    ds_read_b64_tr_b16 v[108:109], v31 offset:12288
    ds_read_b64_tr_b16 v[110:111], v31 offset:12800
    v_mfma_f32_16x16x32_bf16 v[124:127], v[72:75], v[52:55], v[124:127]
    ds_read_b128 v[84:87], v27 offset:0
    ds_read_b128 v[88:91], v27 offset:2048
    v_mfma_f32_16x16x32_bf16 v[128:131], v[72:75], v[56:59], v[128:131]
    ds_read_b128 v[92:95], v27 offset:4096
    ds_read_b128 v[96:99], v27 offset:6144
    v_mfma_f32_16x16x32_bf16 v[132:135], v[72:75], v[60:63], v[132:135]
    ds_read_b128 v[100:103], v27 offset:8192
    ds_read_b128 v[104:107], v27 offset:10240
    v_mfma_f32_16x16x32_bf16 v[136:139], v[72:75], v[64:67], v[136:139]
    ds_read_b64_tr_b16 v[112:113], v31 offset:13312
    ds_read_b64_tr_b16 v[114:115], v31 offset:13824
    v_mfma_f32_16x16x32_bf16 v[140:143], v[72:75], v[68:71], v[140:143]
    ds_read_b64_tr_b16 v[116:117], v31 offset:14336
    ds_read_b64_tr_b16 v[118:119], v31 offset:14848
    v_mfma_f32_16x16x32_bf16 v[144:147], v[76:79], v[48:51], v[144:147]
    v_mfma_f32_16x16x32_bf16 v[148:151], v[76:79], v[52:55], v[148:151]
    v_mfma_f32_16x16x32_bf16 v[152:155], v[76:79], v[56:59], v[152:155]
    v_mfma_f32_16x16x32_bf16 v[156:159], v[76:79], v[60:63], v[156:159]
    v_mfma_f32_16x16x32_bf16 v[160:163], v[76:79], v[64:67], v[160:163]
    v_mfma_f32_16x16x32_bf16 v[164:167], v[76:79], v[68:71], v[164:167]
    s_waitcnt lgkmcnt(0)
    v_mfma_f32_16x16x32_bf16 v[120:123], v[108:111], v[84:87], v[120:123]
    v_mfma_f32_16x16x32_bf16 v[124:127], v[108:111], v[88:91], v[124:127]
    v_mfma_f32_16x16x32_bf16 v[128:131], v[108:111], v[92:95], v[128:131]
    v_mfma_f32_16x16x32_bf16 v[132:135], v[108:111], v[96:99], v[132:135]
    v_mfma_f32_16x16x32_bf16 v[136:139], v[108:111], v[100:103], v[136:139]
    v_mfma_f32_16x16x32_bf16 v[140:143], v[108:111], v[104:107], v[140:143]
    v_mfma_f32_16x16x32_bf16 v[144:147], v[112:115], v[84:87], v[144:147]
    v_mfma_f32_16x16x32_bf16 v[148:151], v[112:115], v[88:91], v[148:151]
    v_mfma_f32_16x16x32_bf16 v[152:155], v[112:115], v[92:95], v[152:155]
    v_mfma_f32_16x16x32_bf16 v[156:159], v[112:115], v[96:99], v[156:159]
    v_mfma_f32_16x16x32_bf16 v[160:163], v[112:115], v[100:103], v[160:163]
    v_mfma_f32_16x16x32_bf16 v[164:167], v[112:115], v[104:107], v[164:167]
    v_mfma_f32_16x16x32_bf16 v[168:171], v[48:51], v[80:83], v[168:171]
    v_mfma_f32_16x16x32_bf16 v[172:175], v[52:55], v[80:83], v[172:175]
    v_mfma_f32_16x16x32_bf16 v[176:179], v[56:59], v[80:83], v[176:179]
    v_cvt_pk_bf16_f32 v192, v120, v121
    v_cvt_pk_bf16_f32 v193, v122, v123
    v_mfma_f32_16x16x32_bf16 v[180:183], v[60:63], v[80:83], v[180:183]
    v_cvt_pk_bf16_f32 v194, v124, v125
    v_cvt_pk_bf16_f32 v195, v126, v127
    v_mfma_f32_16x16x32_bf16 v[184:187], v[64:67], v[80:83], v[184:187]
    v_cvt_pk_bf16_f32 v196, v128, v129
    v_cvt_pk_bf16_f32 v197, v130, v131
    v_mfma_f32_16x16x32_bf16 v[188:191], v[68:71], v[80:83], v[188:191]
    v_cvt_pk_bf16_f32 v198, v132, v133
    v_cvt_pk_bf16_f32 v199, v134, v135
    v_mfma_f32_16x16x32_bf16 v[168:171], v[84:87], v[116:119], v[168:171]
    v_cvt_pk_bf16_f32 v200, v136, v137
    v_cvt_pk_bf16_f32 v201, v138, v139
    v_mfma_f32_16x16x32_bf16 v[172:175], v[88:91], v[116:119], v[172:175]
    v_cvt_pk_bf16_f32 v202, v140, v141
    v_cvt_pk_bf16_f32 v203, v142, v143
    v_mfma_f32_16x16x32_bf16 v[176:179], v[92:95], v[116:119], v[176:179]
    v_cvt_pk_bf16_f32 v204, v144, v145
    v_cvt_pk_bf16_f32 v205, v146, v147
    v_mfma_f32_16x16x32_bf16 v[180:183], v[96:99], v[116:119], v[180:183]
    v_cvt_pk_bf16_f32 v206, v148, v149
    v_cvt_pk_bf16_f32 v207, v150, v151
    v_mfma_f32_16x16x32_bf16 v[184:187], v[100:103], v[116:119], v[184:187]
    v_cvt_pk_bf16_f32 v208, v152, v153
    v_cvt_pk_bf16_f32 v209, v154, v155
    v_mfma_f32_16x16x32_bf16 v[188:191], v[104:107], v[116:119], v[188:191]
    v_cvt_pk_bf16_f32 v210, v156, v157
    v_cvt_pk_bf16_f32 v211, v158, v159
    v_cvt_pk_bf16_f32 v212, v160, v161
    v_cvt_pk_bf16_f32 v213, v162, v163
    v_cvt_pk_bf16_f32 v214, v164, v165
    v_cvt_pk_bf16_f32 v215, v166, v167
    v_mov_b32 v240, 0
    v_mov_b32 v241, 0
    v_mfma_f32_16x16x16_bf16 v[48:51], v[204:205], v[192:193], v[36:39]
    v_cvt_pk_bf16_f32 v242, v168, v169
    v_mfma_f32_16x16x16_bf16 v[52:55], v[206:207], v[194:195], v[36:39]
    v_cvt_pk_bf16_f32 v243, v170, v171
    v_mfma_f32_16x16x16_bf16 v[76:79], v[204:205], v[194:195], v[40:43]
    v_cvt_pk_bf16_f32 v244, v172, v173
    v_mfma_f32_16x16x16_bf16 v[56:59], v[208:209], v[196:197], v[36:39]
    v_cvt_pk_bf16_f32 v245, v174, v175
    v_mfma_f32_16x16x16_bf16 v[80:83], v[206:207], v[196:197], v[40:43]
    v_cvt_pk_bf16_f32 v246, v176, v177
    v_mfma_f32_16x16x16_bf16 v[60:63], v[210:211], v[198:199], v[36:39]
    v_cvt_pk_bf16_f32 v247, v178, v179
    v_mfma_f32_16x16x16_bf16 v[84:87], v[208:209], v[198:199], v[40:43]
    v_cvt_pk_bf16_f32 v248, v180, v181
    v_mfma_f32_16x16x16_bf16 v[64:67], v[212:213], v[200:201], v[36:39]
    v_cvt_pk_bf16_f32 v249, v182, v183
    v_mfma_f32_16x16x16_bf16 v[88:91], v[210:211], v[200:201], v[40:43]
    v_cvt_pk_bf16_f32 v250, v184, v185
    v_mfma_f32_16x16x16_bf16 v[68:71], v[214:215], v[202:203], v[36:39]
    v_cvt_pk_bf16_f32 v251, v186, v187
    v_mfma_f32_16x16x16_bf16 v[92:95], v[212:213], v[202:203], v[40:43]
    v_cvt_pk_bf16_f32 v252, v188, v189
    v_cvt_pk_bf16_f32 v253, v190, v191
    v_max3_f32 v96, v48, v49, v50
    v_max_f32 v96, v96, v51
    v_max_f32 v52, v52, v76
    v_max_f32 v53, v53, v77
    v_max_f32 v54, v54, v78
    v_max_f32 v55, v55, v79
    v_max3_f32 v97, v52, v53, v54
    v_max_f32 v97, v97, v55
    v_max_f32 v56, v56, v80
    v_max_f32 v57, v57, v81
    v_max_f32 v58, v58, v82
    v_max_f32 v59, v59, v83
    v_max3_f32 v98, v56, v57, v58
    v_max_f32 v98, v98, v59
    v_max_f32 v60, v60, v84
    v_max_f32 v61, v61, v85
    v_max_f32 v62, v62, v86
    v_max_f32 v63, v63, v87
    v_max3_f32 v99, v60, v61, v62
    v_max_f32 v99, v99, v63
    v_max_f32 v64, v64, v88
    v_max_f32 v65, v65, v89
    v_max_f32 v66, v66, v90
    v_max_f32 v67, v67, v91
    v_max3_f32 v100, v64, v65, v66
    v_max_f32 v100, v100, v67
    v_max_f32 v68, v68, v92
    v_max_f32 v69, v69, v93
    v_max_f32 v70, v70, v94
    v_max_f32 v71, v71, v95
    v_max3_f32 v101, v68, v69, v70
    v_max_f32 v101, v101, v71
    s_nop 1
    v_permlane32_swap_b32 v96, v97
    v_permlane32_swap_b32 v98, v99
    v_permlane32_swap_b32 v100, v101
    v_max_f32 v96, v96, v97
    v_max_f32 v98, v98, v99
    v_max_f32 v100, v100, v101
    v_mov_b32 v97, v96
    v_mov_b32 v99, v98
    v_mov_b32 v101, v100
    s_nop 0
    v_permlane16_swap_b32 v96, v97
    v_permlane16_swap_b32 v98, v99
    v_permlane16_swap_b32 v100, v101
    v_max_f32 v96, v96, v97
    v_max_f32 v98, v98, v99
    v_max_f32 v100, v100, v101
    v_mul_f32 v96, s34, v96
    v_mul_f32 v98, s34, v98
    v_mul_f32 v100, s34, v100
    v_mov_b32 v97, v96
    v_mov_b32 v99, v98
    v_mov_b32_e64 v101, v100
    s_nop 0
    v_permlane32_swap_b32 v96, v97
    v_permlane32_swap_b32 v98, v99
    v_permlane32_swap_b32 v100, v101
    v_pk_fma_f32 v[48:49], v[48:49], s[24:25], v[96:97] op_sel:[0,0,0] op_sel_hi:[1,1,0] neg_lo:[0,0,1] neg_hi:[0,0,1]
    v_pk_fma_f32 v[50:51], v[50:51], s[24:25], v[96:97] op_sel:[0,0,0] op_sel_hi:[1,1,0] neg_lo:[0,0,1] neg_hi:[0,0,1]
    v_pk_fma_f32 v[52:53], v[52:53], s[24:25], v[96:97] op_sel:[0,0,1] op_sel_hi:[1,1,1] neg_lo:[0,0,1] neg_hi:[0,0,1]
    v_pk_fma_f32 v[54:55], v[54:55], s[24:25], v[96:97] op_sel:[0,0,1] op_sel_hi:[1,1,1] neg_lo:[0,0,1] neg_hi:[0,0,1]
    v_pk_fma_f32 v[56:57], v[56:57], s[24:25], v[98:99] op_sel:[0,0,0] op_sel_hi:[1,1,0] neg_lo:[0,0,1] neg_hi:[0,0,1]
    v_pk_fma_f32 v[58:59], v[58:59], s[24:25], v[98:99] op_sel:[0,0,0] op_sel_hi:[1,1,0] neg_lo:[0,0,1] neg_hi:[0,0,1]
    v_pk_fma_f32 v[60:61], v[60:61], s[24:25], v[98:99] op_sel:[0,0,1] op_sel_hi:[1,1,1] neg_lo:[0,0,1] neg_hi:[0,0,1]
    v_pk_fma_f32 v[62:63], v[62:63], s[24:25], v[98:99] op_sel:[0,0,1] op_sel_hi:[1,1,1] neg_lo:[0,0,1] neg_hi:[0,0,1]
    v_pk_fma_f32 v[64:65], v[64:65], s[24:25], v[100:101] op_sel:[0,0,0] op_sel_hi:[1,1,0] neg_lo:[0,0,1] neg_hi:[0,0,1]
    v_pk_fma_f32 v[66:67], v[66:67], s[24:25], v[100:101] op_sel:[0,0,0] op_sel_hi:[1,1,0] neg_lo:[0,0,1] neg_hi:[0,0,1]
    v_pk_fma_f32 v[68:69], v[68:69], s[24:25], v[100:101] op_sel:[0,0,1] op_sel_hi:[1,1,1] neg_lo:[0,0,1] neg_hi:[0,0,1]
    v_pk_fma_f32 v[70:71], v[70:71], s[24:25], v[100:101] op_sel:[0,0,1] op_sel_hi:[1,1,1] neg_lo:[0,0,1] neg_hi:[0,0,1]
    v_exp_f32 v48, v48
    v_exp_f32 v49, v49
    v_exp_f32 v50, v50
    v_exp_f32 v51, v51
    v_exp_f32 v52, v52
    v_exp_f32 v53, v53
    v_exp_f32 v54, v54
    v_exp_f32 v55, v55
    v_exp_f32 v56, v56
    v_exp_f32 v57, v57
    v_exp_f32 v58, v58
    v_exp_f32 v59, v59
    v_exp_f32 v60, v60
    v_exp_f32 v61, v61
    v_exp_f32 v62, v62
    v_exp_f32 v63, v63
    v_exp_f32 v64, v64
    v_exp_f32 v65, v65
    v_exp_f32 v66, v66
    v_exp_f32 v67, v67
    v_exp_f32 v68, v68
    v_exp_f32 v69, v69
    v_exp_f32 v70, v70
    v_exp_f32 v71, v71
    ds_read_b32 v19, v17 offset:24
    v_cvt_pk_bf16_f32 v108, v48, v49
    v_cvt_pk_bf16_f32 v109, v50, v51
    v_cvt_pk_bf16_f32 v110, v52, v53
    v_cvt_pk_bf16_f32 v111, v54, v55
    v_cvt_pk_bf16_f32 v112, v56, v57
    v_cvt_pk_bf16_f32 v113, v58, v59
    v_cvt_pk_bf16_f32 v114, v60, v61
    v_cvt_pk_bf16_f32 v115, v62, v63
    v_cvt_pk_bf16_f32 v116, v64, v65
    v_cvt_pk_bf16_f32 v117, v66, v67
    v_cvt_pk_bf16_f32 v118, v68, v69
    v_cvt_pk_bf16_f32 v119, v70, v71
    v_and_b32 v122, v108, v44
    v_and_b32 v123, v109, v45
    v_xor_b32 v120, v108, v122
    v_xor_b32 v121, v109, v123
    v_mfma_f32_16x16x16_bf16 v[168:171], v[46:47], v[108:109], 0
    v_and_b32 v126, v110, v44
    v_and_b32 v127, v111, v45
    v_xor_b32 v124, v110, v126
    v_xor_b32 v125, v111, v127
    v_mfma_f32_16x16x16_bf16 v[172:175], v[46:47], v[110:111], 0
    v_and_b32 v130, v112, v44
    v_and_b32 v131, v113, v45
    v_xor_b32 v128, v112, v130
    v_xor_b32 v129, v113, v131
    v_mfma_f32_16x16x16_bf16 v[176:179], v[46:47], v[112:113], 0
    v_and_b32 v134, v114, v44
    v_and_b32 v135, v115, v45
    v_xor_b32 v132, v114, v134
    v_xor_b32 v133, v115, v135
    v_mfma_f32_16x16x16_bf16 v[180:183], v[46:47], v[114:115], 0
    v_and_b32 v138, v116, v44
    v_and_b32 v139, v117, v45
    v_xor_b32 v136, v116, v138
    v_xor_b32 v137, v117, v139
    v_mfma_f32_16x16x16_bf16 v[184:187], v[46:47], v[116:117], 0
    v_and_b32 v142, v118, v44
    v_and_b32 v143, v119, v45
    v_xor_b32 v140, v118, v142
    v_xor_b32 v141, v119, v143
    v_mfma_f32_16x16x16_bf16 v[188:191], v[46:47], v[118:119], 0
    s_nop 0
    v_mfma_f32_16x16x32_bf16 v[144:147], v[240:243], v[120:123], 0
    v_mfma_f32_16x16x32_bf16 v[148:151], v[242:245], v[124:127], 0
    v_mfma_f32_16x16x32_bf16 v[152:155], v[244:247], v[128:131], 0
    v_mfma_f32_16x16x32_bf16 v[156:159], v[246:249], v[132:135], 0
    v_mfma_f32_16x16x32_bf16 v[160:163], v[248:251], v[136:139], 0
    v_mfma_f32_16x16x32_bf16 v[164:167], v[250:253], v[140:143], 0
    s_nop 1
    v_rcp_f32 v96, v168
    v_rcp_f32 v97, v172
    v_rcp_f32 v98, v176
    v_rcp_f32 v99, v180
    v_rcp_f32 v100, v184
    v_rcp_f32 v101, v188
K_A_CW:
    s_waitcnt lgkmcnt(0)
    v_cmp_eq_u32 vcc, 1, v19
    s_cmp_lg_u64 vcc, 0
    s_cbranch_scc1 K_A_CWX
    ds_read_b32 v19, v17 offset:24
    s_branch K_A_CW
K_A_CWX:
    s_nop 1
    v_pk_mul_f32 v[144:145], v[144:145], v[96:97] op_sel:[0,0] op_sel_hi:[1,0]
    v_pk_mul_f32 v[146:147], v[146:147], v[96:97] op_sel:[0,0] op_sel_hi:[1,0]
    v_pk_mul_f32 v[148:149], v[148:149], v[96:97] op_sel:[0,1] op_sel_hi:[1,1]
    v_pk_mul_f32 v[150:151], v[150:151], v[96:97] op_sel:[0,1] op_sel_hi:[1,1]
    v_cvt_pk_bf16_f32 v192, v144, v145
    v_cvt_pk_bf16_f32 v193, v146, v147
    v_cvt_pk_bf16_f32 v194, v148, v149
    v_cvt_pk_bf16_f32 v195, v150, v151
    s_nop 1
    v_permlane16_swap_b32 v192, v194
    v_permlane16_swap_b32 v193, v195
    buffer_store_dwordx4 v[192:195], v32, s[8:11], s60 offen
    v_pk_mul_f32 v[152:153], v[152:153], v[98:99] op_sel:[0,0] op_sel_hi:[1,0]
    v_pk_mul_f32 v[154:155], v[154:155], v[98:99] op_sel:[0,0] op_sel_hi:[1,0]
    v_pk_mul_f32 v[156:157], v[156:157], v[98:99] op_sel:[0,1] op_sel_hi:[1,1]
    v_pk_mul_f32 v[158:159], v[158:159], v[98:99] op_sel:[0,1] op_sel_hi:[1,1]
    v_cvt_pk_bf16_f32 v196, v152, v153
    v_cvt_pk_bf16_f32 v197, v154, v155
    v_cvt_pk_bf16_f32 v198, v156, v157
    v_cvt_pk_bf16_f32 v199, v158, v159
    s_nop 1
    v_permlane16_swap_b32 v196, v198
    v_permlane16_swap_b32 v197, v199
    buffer_store_dwordx4 v[196:199], v32, s[8:11], s61 offen
    v_pk_mul_f32 v[160:161], v[160:161], v[100:101] op_sel:[0,0] op_sel_hi:[1,0]
    v_pk_mul_f32 v[162:163], v[162:163], v[100:101] op_sel:[0,0] op_sel_hi:[1,0]
    v_pk_mul_f32 v[164:165], v[164:165], v[100:101] op_sel:[0,1] op_sel_hi:[1,1]
    v_pk_mul_f32 v[166:167], v[166:167], v[100:101] op_sel:[0,1] op_sel_hi:[1,1]
    v_cvt_pk_bf16_f32 v200, v160, v161
    v_cvt_pk_bf16_f32 v201, v162, v163
    v_cvt_pk_bf16_f32 v202, v164, v165
    v_cvt_pk_bf16_f32 v203, v166, v167
    s_nop 1
    v_permlane16_swap_b32 v200, v202
    v_permlane16_swap_b32 v201, v203
    buffer_store_dwordx4 v[200:203], v32, s[8:11], s62 offen
    s_mov_b64 exec, 1
    ds_add_u32 v17, v34 offset:8
    s_mov_b64 exec, -1
    s_waitcnt vmcnt(0)
    s_mov_b64 exec, 1
    buffer_store_dword v33, v18, s[16:19], s58 offen
K_A_NOSIG:
    s_mov_b64 exec, -1
    s_setprio 0
    v_mov_b32 v7, 147456
    s_barrier
    ds_read_b32 v8, v7
    s_waitcnt lgkmcnt(0)
    v_readfirstlane_b32 s6, v8
    s_cmp_eq_u32 s6, 0
    s_cbranch_scc1 K_A_CDONE
    buffer_store_dwordx4 v[192:195], v32, s[8:11], s60 offen sc1
    buffer_store_dwordx4 v[196:199], v32, s[8:11], s61 offen sc1
    buffer_store_dwordx4 v[200:203], v32, s[8:11], s62 offen sc1
    v_cmp_eq_u32 vcc, 0, v2
    s_and_saveexec_b64 s[6:7], vcc
    s_waitcnt vmcnt(0)
    ds_add_rtn_u32 v8, v7, v34 offset:4
    s_waitcnt lgkmcnt(0)
    v_readfirstlane_b32 s28, v8
    s_cmp_lg_u32 s28, 3
    s_cbranch_scc1 K_A_CDONE
    s_add_u32 s58, s58, 24576
    v_mov_b32 v7, 0
    buffer_store_dword v34, v7, s[16:19], s58 offen sc1
K_A_CDONE:
    s_mov_b64 exec, -1
    s_endpgm
.fill 188, 4, 0xbf800000
K_B_GEN:
    s_and_b32 s30, s5, 1
    s_lshl_b32 s30, s30, 2
    s_add_u32 s58, s30, s32
    s_and_b32 s6, s5, 4
    s_lshl_b32 s31, s6, 1
    s_lshl_b32 s96, s6, 8
    s_cmp_eq_u32 s4, 0
    s_cselect_b32 s31, s31, s4
    s_cselect_b32 s96, 0, s96
    s_add_u32 s96, s96, s31
    v_lshrrev_b32 v7, 2, v2
    v_and_b32 v8, 3, v2
    v_lshlrev_b32 v7, 6, v7
    v_lshl_add_u32 v7, v8, 3, v7
    v_and_b32 v8, 1, v4
    v_lshl_add_u32 v7, v8, 5, v7
    v_add_u32 v17, s35, v7
    v_xor_b32 v26, 32, v17
    v_bfe_u32 v7, v2, 3, 1
    v_lshl_add_u32 v7, v7, 2, v4
    v_xor_b32 v7, v7, v6
    v_lshlrev_b32 v7, 4, v7
    v_lshl_add_u32 v18, v6, 12, v7
    s_lshl_b32 s6, s3, 9
    s_add_u32 s6, s6, 65536
    v_add_u32 v18, s6, v18
    s_mul_i32 s6, s33, 48
    v_xor_b32 v18, s6, v18
    v_xor_b32 v27, 32, v18
    v_bfe_u32 v8, v2, 3, 1
    v_mul_u32_u24 v8, 3, v8
    v_and_b32 v9, 4, v2
    v_lshrrev_b32 v9, 1, v9
    v_xor_b32 v8, v8, v9
    v_xor_b32 v8, v8, v4
    v_lshlrev_b32 v7, 6, v3
    v_lshl_add_u32 v7, v8, 4, v7
    s_lshl_b32 s6, s32, 5
    v_xor_b32 v7, s6, v7
    s_lshl_b32 s6, s32, 13
    s_add_u32 s6, s6, 65536
    v_add_u32 v19, s6, v7
    v_xor_b32 v20, 16, v19
    s_mov_b32 s6, 589824
    v_mul_lo_u32 v7, v4, s6
    v_lshl_add_u32 v22, v3, 4, v7
    s_mul_i32 s101, s29, 4608
    s_lshl_b32 s6, s33, 8
    s_add_u32 s101, s101, s6
    s_lshl_b32 s6, s58, 9
    s_add_u32 s101, s101, s6
    s_lshl_b32 s6, s30, 1
    v_add_u32 v9, s6, v6
    v_cmp_eq_u32 vcc, 1, v9
    v_mov_b32 v23, 16
    v_cvt_f32_u32 v25, v3
    v_cndmask_b32 v9, v9, v23, vcc
    v_lshrrev_b32 v7, 1, v9
    v_and_b32 v8, 1, v9
    v_cvt_f32_u32 v7, v7
    v_cvt_f32_u32 v8, v8
    v_cvt_f32_u32 v9, v4
    v_mul_f32 v7, 0x3d800000, v7
    v_mul_f32 v25, 0x3d800000, v25
    v_mul_f32 v9, 4.0, v9
    v_mul_f32 v24, 0x3e800000, v8
    v_fmac_f32 v24, v7, v9
    v_mul_f32 v23, v25, v9
    v_cos_f32 v96, v24
    v_cos_f32 v100, v23
    v_sin_f32 v104, v23
    v_add_f32 v24, v24, v7
    v_add_f32 v23, v23, v25
    v_cos_f32 v97, v24
    v_cos_f32 v101, v23
    v_sin_f32 v105, v23
    v_add_f32 v24, v24, v7
    v_add_f32 v23, v23, v25
    v_cos_f32 v98, v24
    v_cos_f32 v102, v23
    v_sin_f32 v106, v23
    v_add_f32 v24, v24, v7
    v_add_f32 v23, v23, v25
    v_cos_f32 v99, v24
    v_cos_f32 v103, v23
    v_sin_f32 v107, v23
    v_cmp_lt_u32 vcc, 7, v3
    v_cvt_pk_bf16_f32 v24, v96, v97
    v_cvt_pk_bf16_f32 v25, v98, v99
    v_cndmask_b32 v32, v24, v14, vcc
    v_cndmask_b32 v33, v25, v14, vcc
    v_cndmask_b32 v34, v14, v24, vcc
    v_cndmask_b32_e64 v35, v14, v25, vcc
    v_cvt_pk_bf16_f32 v38, v100, v101
    v_cvt_pk_bf16_f32 v39, v102, v103
    v_cvt_pk_bf16_f32 v40, v104, v105
    v_cvt_pk_bf16_f32 v41, v106, v107
    v_xor_b32 v42, 0x80008000, v38
    v_xor_b32 v43, 0x80008000, v39
    s_lshl_b32 s6, s33, 8
    s_add_u32 s6, s6, s58
    s_add_u32 s6, s6, 0
    v_lshl_add_u32 v7, v3, 4, s6
    v_cvt_f32_u32 v7, v7
    v_mul_f32 v7, 0xbb000000, v7
    v_lshlrev_b32 v8, 2, v4
    v_cvt_f32_u32 v8, v8
    v_mul_f32 v8, v7, v8
    v_mul_f32 v9, 0x41500000, v7
    v_cos_f32 v96, v8
    v_sin_f32 v104, v8
    v_add_f32 v8, v8, v7
    v_cos_f32 v97, v8
    v_sin_f32 v105, v8
    v_add_f32 v8, v8, v7
    v_cos_f32 v98, v8
    v_sin_f32 v106, v8
    v_add_f32 v8, v8, v7
    v_cos_f32 v99, v8
    v_sin_f32 v107, v8
    v_add_f32 v8, v8, v9
    v_cos_f32 v100, v8
    v_sin_f32 v108, v8
    v_add_f32 v8, v8, v7
    v_cos_f32 v101, v8
    v_sin_f32 v109, v8
    v_add_f32 v8, v8, v7
    v_cos_f32 v102, v8
    v_sin_f32 v110, v8
    v_add_f32 v8, v8, v7
    v_cos_f32 v103, v8
    v_sin_f32_e64 v111, v8
    s_nop 0
    v_cvt_pk_bf16_f32 v44, v96, v97
    v_cvt_pk_bf16_f32 v45, v98, v99
    v_cvt_pk_bf16_f32 v46, v100, v101
    v_cvt_pk_bf16_f32 v47, v102, v103
    v_cvt_pk_bf16_f32 v48, v104, v105
    v_cvt_pk_bf16_f32 v49, v106, v107
    v_cvt_pk_bf16_f32 v50, v108, v109
    v_cvt_pk_bf16_f32 v51, v110, v111
    v_xor_b32 v52, 0x80008000, v48
    v_xor_b32 v53, 0x80008000, v49
    v_xor_b32 v54, 0x80008000, v50
    v_xor_b32 v55, 0x80008000, v51
    s_cmp_lg_u32 s58, 0
    s_cbranch_scc1 K_B_NOM8
    s_lshl_b32 s6, s33, 8
    s_add_u32 s6, s6, s58
    s_add_u32 s6, s6, 8
    v_lshl_add_u32 v7, v3, 4, s6
    v_cvt_f32_u32 v7, v7
    v_mul_f32 v7, 0xbb000000, v7
    v_lshlrev_b32 v8, 2, v4
    v_cvt_f32_u32 v8, v8
    v_mul_f32 v8, v7, v8
    v_mul_f32 v9, 0x41500000, v7
    v_cos_f32 v96, v8
    v_sin_f32 v104, v8
    v_add_f32 v8, v8, v7
    v_cos_f32 v97, v8
    v_sin_f32 v105, v8
    v_add_f32 v8, v8, v7
    v_cos_f32 v98, v8
    v_sin_f32 v106, v8
    v_add_f32 v8, v8, v7
    v_cos_f32 v99, v8
    v_sin_f32 v107, v8
    v_add_f32 v8, v8, v9
    v_cos_f32 v100, v8
    v_sin_f32 v108, v8
    v_add_f32 v8, v8, v7
    v_cos_f32 v101, v8
    v_sin_f32 v109, v8
    v_add_f32 v8, v8, v7
    v_cos_f32 v102, v8
    v_sin_f32 v110, v8
    v_add_f32 v8, v8, v7
    v_cos_f32 v103, v8
    v_sin_f32_e64 v111, v8
    s_nop 0
    v_cvt_pk_bf16_f32 v52, v96, v97
    v_cvt_pk_bf16_f32 v53, v98, v99
    v_cvt_pk_bf16_f32 v54, v100, v101
    v_cvt_pk_bf16_f32 v55, v102, v103
    v_cvt_pk_bf16_f32 v56, v104, v105
    v_cvt_pk_bf16_f32 v57, v106, v107
    v_cvt_pk_bf16_f32 v58, v108, v109
    v_cvt_pk_bf16_f32 v59, v110, v111
K_B_NOM8:
    s_cmp_ge_u32 s3, 4
    s_cbranch_scc1 K_B_GEN2
    s_xor_b32 s34, s34, 2048
    s_xor_b32 s97, s97, 0x8000
    s_add_u32 m0, s97, 0
    s_add_u32 s6, s34, 0
    buffer_load_dwordx4 v37, s[20:23], s6 offen lds
    s_add_u32 m0, s97, 1024
    s_add_u32 s6, s34, 131072
    buffer_load_dwordx4 v37, s[20:23], s6 offen lds
    s_add_u32 m0, s97, 2048
    s_add_u32 s6, s34, 262144
    buffer_load_dwordx4 v37, s[20:23], s6 offen lds
    s_add_u32 m0, s97, 3072
    s_add_u32 s6, s34, 393216
    buffer_load_dwordx4 v37, s[20:23], s6 offen lds
    s_add_u32 m0, s97, 4096
    s_add_u32 s6, s34, 524288
    buffer_load_dwordx4 v37, s[20:23], s6 offen lds
    s_add_u32 m0, s97, 5120
    s_add_u32 s6, s34, 655360
    buffer_load_dwordx4 v37, s[20:23], s6 offen lds
    s_add_u32 m0, s97, 6144
    s_add_u32 s6, s34, 786432
    buffer_load_dwordx4 v37, s[20:23], s6 offen lds
    s_add_u32 m0, s97, 7168
    s_add_u32 s6, s34, 917504
    buffer_load_dwordx4 v37, s[20:23], s6 offen lds
    s_sub_u32 s28, s59, 0x180000
    s_cselect_b32 s59, s59, s28
    buffer_load_dwordx4 v[244:247], v10, s[12:15], s59 offen offset:384
    s_add_u32 s59, s59, 0x40000
    s_sub_u32 s28, s59, 0x180000
    s_cselect_b32 s59, s59, s28
    buffer_load_dwordx4 v[244:247], v10, s[12:15], s59 offen offset:384
    s_add_u32 s59, s59, 0x40000
    s_sub_u32 s28, s59, 0x180000
    s_cselect_b32 s59, s59, s28
    buffer_load_dwordx4 v[244:247], v10, s[12:15], s59 offen offset:384
    s_add_u32 s59, s59, 0x40000
    s_sub_u32 s28, s59, 0x180000
    s_cselect_b32 s59, s59, s28
    buffer_load_dwordx4 v[244:247], v10, s[12:15], s59 offen offset:384
    s_add_u32 s59, s59, 0x40000
    s_sub_u32 s28, s59, 0x180000
    s_cselect_b32 s59, s59, s28
    buffer_load_dwordx4 v[244:247], v10, s[12:15], s59 offen offset:384
    s_add_u32 s59, s59, 0x40000
    s_mov_b32 s12, s40
    s_mov_b32 s13, s41
    s_mov_b32 s14, 0x80000
    s_mov_b32 s15, 0x20000
    s_lshl_b32 s28, s4, 3
    s_add_u32 s28, s28, s5
    s_lshl_b32 s28, s28, 2
    s_add_u32 s28, s28, s3
    s_lshl_b32 s28, s28, 11
    buffer_load_dwordx4 v[244:247], v36, s[12:15], s28 offen
    buffer_load_dwordx4 v[244:247], v36, s[12:15], s28 offen offset:1024
K_B_GEN2:
    s_waitcnt vmcnt(7)
    s_cmp_lt_u32 s3, 4
    s_cbranch_scc1 K_B_XOK
    s_sub_u32 s6, s3, 4
    s_lshl_b32 s6, s6, 8
    s_add_u32 s6, s6, s96
    v_lshl_add_u32 v7, v3, 4, s6
    v_cvt_f32_u32 v7, v7
    v_mul_f32 v240, 0xba000000, v7
    v_mul_f32 v241, 0x41500000, v240
    s_and_b32 s6, s5, 4
    s_lshl_b32 s6, s6, 4
    v_lshl_add_u32 v8, v4, 2, s6
    v_cvt_f32_u32 v242, v8
    s_lshl_b32 s6, s3, 13
    s_add_u32 s6, s6, 65536
    v_add_u32 v243, s6, v36
    s_mov_b32 s7, 0
    s_mov_b32 s6, 0x43000000
K_B_GL1:
    v_mul_f32 v9, v240, v242
    v_cos_f32 v96, v9
    v_sin_f32 v100, v9
    v_add_f32 v9, v9, v240
    v_cos_f32 v97, v9
    v_sin_f32 v101, v9
    v_add_f32 v9, v9, v240
    v_cos_f32 v98, v9
    v_sin_f32 v102, v9
    v_add_f32 v9, v9, v240
    v_cos_f32 v99, v9
    v_sin_f32 v103, v9
    v_add_f32 v9, v9, v241
    v_cos_f32 v104, v9
    v_sin_f32 v108, v9
    v_add_f32 v9, v9, v240
    v_cos_f32 v105, v9
    v_sin_f32 v109, v9
    v_add_f32 v9, v9, v240
    v_cos_f32 v106, v9
    v_sin_f32 v110, v9
    v_add_f32 v9, v9, v240
    v_cos_f32 v107, v9
    v_sin_f32_e64 v111, v9
    v_add_f32 v242, 0x42000000, v242
    v_cvt_pk_bf16_f32 v112, v96, v97
    v_cvt_pk_bf16_f32 v113, v98, v99
    v_cvt_pk_bf16_f32 v114, v100, v101
    v_cvt_pk_bf16_f32 v115, v102, v103
    ds_write_b128 v243, v[112:115] offset:0
    v_cvt_pk_bf16_f32 v116, v104, v105
    v_cvt_pk_bf16_f32 v117, v106, v107
    v_cvt_pk_bf16_f32 v118, v108, v109
    v_cvt_pk_bf16_f32 v119, v110, v111
    ds_write_b128 v243, v[116:119] offset:1024
    v_cmp_le_f32 vcc, s6, v242
    v_add_u32 v243, 2048, v243
    v_subrev_f32 v9, s6, v242
    s_add_u32 s7, s7, 1
    v_cndmask_b32 v242, v242, v9, vcc
    s_cmp_lt_u32 s7, 3
    s_cbranch_scc1 K_B_GL1
K_B_XOK:
    s_waitcnt lgkmcnt(0)
    s_add_u32 s8, s56, 0x280000
    s_addc_u32 s9, s57, 0
    s_mov_b32 s10, 0x240000
    s_mov_b32 s11, 0x20000
    s_mov_b32 s12, s52
    s_mov_b32 s13, s53
    s_mov_b32 s14, 0x400000
    s_mov_b32 s15, 0x20000
    s_add_u32 s60, s56, 0x500000
    s_addc_u32 s61, s57, 0
    s_mov_b32 s62, 0x10000
    s_mov_b32 s63, 0x20000
    s_mov_b32 s16, s54
    s_mov_b32 s17, s55
    s_mov_b32 s18, 0x100
    s_mov_b32 s19, 0x20000
    s_mov_b32 s20, s40
    s_mov_b32 s21, s41
    s_mov_b32 s22, 0x80000
    s_mov_b32 s23, 0x20000
    s_lshl_b32 s28, s5, 3
    s_add_u32 s28, s28, s3
    s_lshl_b32 s28, s28, 13
    s_add_u32 s97, s28, 4096
    s_barrier
    ds_read_b64_tr_b16 v[64:65], v17 offset:0
    ds_read_b64_tr_b16 v[66:67], v17 offset:1024
    ds_read_b64_tr_b16 v[68:69], v26 offset:0
    ds_read_b64_tr_b16 v[70:71], v26 offset:1024
    ds_read_b64_tr_b16 v[72:73], v17 offset:2048
    ds_read_b64_tr_b16 v[74:75], v17 offset:3072
    ds_read_b64_tr_b16 v[76:77], v26 offset:2048
    ds_read_b64_tr_b16 v[78:79], v26 offset:3072
    ds_read_b64_tr_b16 v[80:81], v17 offset:4096
    ds_read_b64_tr_b16 v[82:83], v17 offset:5120
    ds_read_b64_tr_b16 v[84:85], v26 offset:4096
    ds_read_b64_tr_b16 v[86:87], v26 offset:5120
    ds_read_b64_tr_b16 v[88:89], v17 offset:6144
    ds_read_b64_tr_b16 v[90:91], v17 offset:7168
    ds_read_b64_tr_b16 v[92:93], v26 offset:6144
    ds_read_b64_tr_b16 v[94:95], v26 offset:7168
    s_waitcnt lgkmcnt(14)
    v_mfma_f32_16x16x32_bf16 v[96:99], v[64:67], v[32:35], 0
    s_waitcnt lgkmcnt(12)
    v_mfma_f32_16x16x32_bf16 v[100:103], v[68:71], v[32:35], 0
    s_waitcnt lgkmcnt(10)
    v_mfma_f32_16x16x32_bf16 v[104:107], v[72:75], v[32:35], 0
    s_waitcnt lgkmcnt(8)
    v_mfma_f32_16x16x32_bf16 v[108:111], v[76:79], v[32:35], 0
    s_waitcnt lgkmcnt(6)
    v_mfma_f32_16x16x32_bf16 v[112:115], v[80:83], v[32:35], 0
    s_waitcnt lgkmcnt(4)
    v_mfma_f32_16x16x32_bf16 v[116:119], v[84:87], v[32:35], 0
    s_waitcnt lgkmcnt(2)
    v_mfma_f32_16x16x32_bf16 v[120:123], v[88:91], v[32:35], 0
    v_cvt_pk_bf16_f32 v128, v96, v97
    v_cvt_pk_bf16_f32 v129, v98, v99
    s_waitcnt lgkmcnt(0)
    v_mfma_f32_16x16x32_bf16 v[124:127], v[92:95], v[32:35], 0
    v_cvt_pk_bf16_f32 v130, v100, v101
    v_cvt_pk_bf16_f32 v131, v102, v103
    ds_write_b128 v18, v[128:131] offset:0
    v_cvt_pk_bf16_f32 v132, v104, v105
    v_cvt_pk_bf16_f32 v133, v106, v107
    v_cvt_pk_bf16_f32 v134, v108, v109
    v_cvt_pk_bf16_f32 v135, v110, v111
    ds_write_b128 v18, v[132:135] offset:128
    v_cvt_pk_bf16_f32 v136, v112, v113
    v_cvt_pk_bf16_f32 v137, v114, v115
    v_cvt_pk_bf16_f32 v138, v116, v117
    v_cvt_pk_bf16_f32 v139, v118, v119
    ds_write_b128 v27, v[136:139] offset:256
    v_cvt_pk_bf16_f32 v140, v120, v121
    v_cvt_pk_bf16_f32 v141, v122, v123
    v_cvt_pk_bf16_f32 v142, v124, v125
    v_cvt_pk_bf16_f32 v143, v126, v127
    ds_write_b128 v27, v[140:143] offset:384
    s_waitcnt lgkmcnt(0)
    s_barrier
    ds_read_b128 v[64:67], v19 offset:0
    ds_read_b128 v[80:83], v20 offset:4096
    ds_read_b128 v[68:71], v19 offset:1024
    ds_read_b128 v[84:87], v20 offset:5120
    ds_read_b128 v[72:75], v19 offset:2048
    ds_read_b128 v[88:91], v20 offset:6144
    ds_read_b128 v[76:79], v19 offset:3072
    ds_read_b128 v[92:95], v20 offset:7168
    s_cmp_eq_u32 s58, 0
    s_cbranch_scc1 K_B_W0
    s_waitcnt lgkmcnt(6)
    v_mfma_f32_16x16x32_bf16 v[96:99], v[64:67], v[44:47], 0
    v_mfma_f32_16x16x32_bf16 v[100:103], v[64:67], v[48:51], 0
    v_mfma_f32_16x16x32_bf16 v[96:99], v[80:83], v[52:55], v[96:99]
    v_mfma_f32_16x16x32_bf16 v[100:103], v[80:83], v[44:47], v[100:103]
    s_waitcnt lgkmcnt(4)
    v_mfma_f32_16x16x32_bf16 v[104:107], v[68:71], v[44:47], 0
    v_mfma_f32_16x16x32_bf16 v[108:111], v[68:71], v[48:51], 0
    v_mfma_f32_16x16x32_bf16 v[104:107], v[84:87], v[52:55], v[104:107]
    v_mfma_f32_16x16x32_bf16 v[108:111], v[84:87], v[44:47], v[108:111]
    s_waitcnt lgkmcnt(2)
    v_mfma_f32_16x16x32_bf16 v[112:115], v[72:75], v[44:47], 0
    v_mfma_f32_16x16x32_bf16 v[116:119], v[72:75], v[48:51], 0
    v_mfma_f32_16x16x32_bf16 v[112:115], v[88:91], v[52:55], v[112:115]
    v_mfma_f32_16x16x32_bf16 v[116:119], v[88:91], v[44:47], v[116:119]
    s_waitcnt lgkmcnt(0)
    v_mfma_f32_16x16x32_bf16 v[120:123], v[76:79], v[44:47], 0
    v_cvt_pk_bf16_f32 v160, v96, v97
    v_cvt_pk_bf16_f32 v161, v98, v99
    v_mfma_f32_16x16x32_bf16 v[124:127], v[76:79], v[48:51], 0
    v_cvt_pk_bf16_f32 v162, v100, v101
    v_cvt_pk_bf16_f32 v163, v102, v103
    v_mfma_f32_16x16x32_bf16 v[120:123], v[92:95], v[52:55], v[120:123]
    v_cvt_pk_bf16_f32 v164, v104, v105
    v_cvt_pk_bf16_f32 v165, v106, v107
    v_mfma_f32_16x16x32_bf16 v[124:127], v[92:95], v[44:47], v[124:127]
    v_cvt_pk_bf16_f32 v166, v108, v109
    v_cvt_pk_bf16_f32 v167, v110, v111
    v_mfma_f32_16x16x32_bf16 v[192:195], v[38:41], v[160:163], 0
    v_cvt_pk_bf16_f32 v168, v112, v113
    v_cvt_pk_bf16_f32 v169, v114, v115
    v_mfma_f32_16x16x32_bf16 v[208:211], v[40:43], v[160:163], 0
    v_cvt_pk_bf16_f32 v170, v116, v117
    v_cvt_pk_bf16_f32 v171, v118, v119
    v_mfma_f32_16x16x32_bf16 v[196:199], v[38:41], v[164:167], 0
    s_nop 0
    v_cvt_pk_bf16_f32 v172, v120, v121
    v_mfma_f32_16x16x32_bf16 v[212:215], v[40:43], v[164:167], 0
    v_cvt_pk_bf16_f32 v173, v122, v123
    v_cvt_pk_bf16_f32 v174, v124, v125
    v_cvt_pk_bf16_f32 v175, v126, v127
    s_nop 0
    v_mfma_f32_16x16x32_bf16 v[200:203], v[38:41], v[168:171], 0
    v_mfma_f32_16x16x32_bf16 v[216:219], v[40:43], v[168:171], 0
    v_mfma_f32_16x16x32_bf16 v[204:207], v[38:41], v[172:175], 0
    v_mfma_f32_16x16x32_bf16 v[220:223], v[40:43], v[172:175], 0
    s_nop 1
    v_cvt_pk_bf16_f32 v224, v192, v196
    v_cvt_pk_bf16_f32 v226, v208, v212
    v_cvt_pk_bf16_f32 v228, v193, v197
    v_cvt_pk_bf16_f32 v230, v209, v213
    v_cvt_pk_bf16_f32 v232, v194, v198
    v_cvt_pk_bf16_f32 v234, v210, v214
    v_cvt_pk_bf16_f32 v236, v195, v199
    v_cvt_pk_bf16_f32 v238, v211, v215
    v_cvt_pk_bf16_f32 v225, v200, v204
    v_cvt_pk_bf16_f32 v227, v216, v220
    s_add_u32 s7, s101, 0
    buffer_store_dwordx4 v[224:227], v22, s[8:11], s7 offen sc1
    v_cvt_pk_bf16_f32 v229, v201, v205
    v_cvt_pk_bf16_f32 v231, v217, v221
    s_add_u32 s7, s101, 147456
    buffer_store_dwordx4 v[228:231], v22, s[8:11], s7 offen sc1
    v_cvt_pk_bf16_f32 v233, v202, v206
    v_cvt_pk_bf16_f32 v235, v218, v222
    s_add_u32 s7, s101, 294912
    buffer_store_dwordx4 v[232:235], v22, s[8:11], s7 offen sc1
    v_cvt_pk_bf16_f32 v237, v203, v207
    v_cvt_pk_bf16_f32 v239, v219, v223
    s_add_u32 s7, s101, 442368
    buffer_store_dwordx4 v[236:239], v22, s[8:11], s7 offen sc1
    s_branch K_B_SIG
K_B_W0:
    s_waitcnt lgkmcnt(7)
    v_mfma_f32_16x16x32_bf16 v[96:99], v[64:67], v[44:47], 0
    v_mfma_f32_16x16x32_bf16 v[100:103], v[64:67], v[48:51], 0
    s_waitcnt lgkmcnt(5)
    v_mfma_f32_16x16x32_bf16 v[104:107], v[68:71], v[44:47], 0
    v_mfma_f32_16x16x32_bf16 v[108:111], v[68:71], v[48:51], 0
    s_waitcnt lgkmcnt(3)
    v_mfma_f32_16x16x32_bf16 v[112:115], v[72:75], v[44:47], 0
    v_mfma_f32_16x16x32_bf16 v[116:119], v[72:75], v[48:51], 0
    s_waitcnt lgkmcnt(1)
    v_mfma_f32_16x16x32_bf16 v[120:123], v[76:79], v[44:47], 0
    v_mfma_f32_16x16x32_bf16 v[124:127], v[76:79], v[48:51], 0
    s_waitcnt lgkmcnt(0)
    v_mfma_f32_16x16x32_bf16 v[128:131], v[80:83], v[52:55], 0
    v_cvt_pk_bf16_f32 v160, v96, v97
    v_cvt_pk_bf16_f32 v161, v98, v99
    v_mfma_f32_16x16x32_bf16 v[132:135], v[80:83], v[56:59], 0
    v_cvt_pk_bf16_f32 v162, v100, v101
    v_cvt_pk_bf16_f32 v163, v102, v103
    v_mfma_f32_16x16x32_bf16 v[136:139], v[84:87], v[52:55], 0
    v_cvt_pk_bf16_f32 v164, v104, v105
    v_cvt_pk_bf16_f32 v165, v106, v107
    v_mfma_f32_16x16x32_bf16 v[140:143], v[84:87], v[56:59], 0
    v_cvt_pk_bf16_f32 v166, v108, v109
    v_cvt_pk_bf16_f32 v167, v110, v111
    v_mfma_f32_16x16x32_bf16 v[144:147], v[88:91], v[52:55], 0
    v_cvt_pk_bf16_f32 v168, v112, v113
    v_cvt_pk_bf16_f32 v169, v114, v115
    v_mfma_f32_16x16x32_bf16 v[148:151], v[88:91], v[56:59], 0
    v_cvt_pk_bf16_f32 v170, v116, v117
    v_cvt_pk_bf16_f32 v171, v118, v119
    v_mfma_f32_16x16x32_bf16 v[152:155], v[92:95], v[52:55], 0
    v_cvt_pk_bf16_f32 v172, v120, v121
    v_cvt_pk_bf16_f32 v173, v122, v123
    v_mfma_f32_16x16x32_bf16 v[156:159], v[92:95], v[56:59], 0
    v_cvt_pk_bf16_f32 v174, v124, v125
    v_cvt_pk_bf16_f32 v175, v126, v127
    v_mfma_f32_16x16x32_bf16 v[192:195], v[38:41], v[160:163], 0
    v_cvt_pk_bf16_f32 v176, v128, v129
    v_cvt_pk_bf16_f32 v177, v130, v131
    v_mfma_f32_16x16x32_bf16 v[208:211], v[40:43], v[160:163], 0
    v_cvt_pk_bf16_f32 v178, v132, v133
    v_cvt_pk_bf16_f32 v179, v134, v135
    v_mfma_f32_16x16x32_bf16 v[196:199], v[38:41], v[164:167], 0
    v_cvt_pk_bf16_f32 v180, v136, v137
    v_cvt_pk_bf16_f32 v181, v138, v139
    v_mfma_f32_16x16x32_bf16 v[212:215], v[40:43], v[164:167], 0
    v_cvt_pk_bf16_f32 v182, v140, v141
    v_cvt_pk_bf16_f32 v183, v142, v143
    v_mfma_f32_16x16x32_bf16 v[200:203], v[38:41], v[168:171], 0
    v_cvt_pk_bf16_f32 v184, v144, v145
    v_cvt_pk_bf16_f32 v185, v146, v147
    v_mfma_f32_16x16x32_bf16 v[216:219], v[40:43], v[168:171], 0
    v_cvt_pk_bf16_f32 v186, v148, v149
    v_cvt_pk_bf16_f32 v187, v150, v151
    v_mfma_f32_16x16x32_bf16 v[204:207], v[38:41], v[172:175], 0
    v_cvt_pk_bf16_f32 v188, v152, v153
    v_cvt_pk_bf16_f32 v189, v154, v155
    v_mfma_f32_16x16x32_bf16 v[220:223], v[40:43], v[172:175], 0
    v_cvt_pk_bf16_f32 v190, v156, v157
    v_cvt_pk_bf16_f32 v191, v158, v159
    v_mfma_f32_16x16x32_bf16 v[64:67], v[38:41], v[176:179], 0
    v_cvt_pk_bf16_f32 v224, v192, v196
    v_mfma_f32_16x16x32_bf16 v[80:83], v[40:43], v[176:179], 0
    v_cvt_pk_bf16_f32 v226, v208, v212
    v_mfma_f32_16x16x32_bf16 v[68:71], v[38:41], v[180:183], 0
    v_cvt_pk_bf16_f32 v228, v193, v197
    v_mfma_f32_16x16x32_bf16 v[84:87], v[40:43], v[180:183], 0
    v_cvt_pk_bf16_f32 v230, v209, v213
    v_mfma_f32_16x16x32_bf16 v[72:75], v[38:41], v[184:187], 0
    v_cvt_pk_bf16_f32 v232, v194, v198
    v_mfma_f32_16x16x32_bf16 v[88:91], v[40:43], v[184:187], 0
    v_cvt_pk_bf16_f32 v234, v210, v214
    v_mfma_f32_16x16x32_bf16 v[76:79], v[38:41], v[188:191], 0
    v_cvt_pk_bf16_f32 v236, v195, v199
    v_mfma_f32_16x16x32_bf16 v[92:95], v[40:43], v[188:191], 0
    v_cvt_pk_bf16_f32 v238, v211, v215
    v_cvt_pk_bf16_f32 v225, v200, v204
    v_cvt_pk_bf16_f32 v227, v216, v220
    s_add_u32 s7, s101, 0
    buffer_store_dwordx4 v[224:227], v22, s[8:11], s7 offen sc1
    v_cvt_pk_bf16_f32 v229, v201, v205
    v_cvt_pk_bf16_f32 v231, v217, v221
    s_add_u32 s7, s101, 147456
    buffer_store_dwordx4 v[228:231], v22, s[8:11], s7 offen sc1
    v_cvt_pk_bf16_f32 v233, v202, v206
    v_cvt_pk_bf16_f32 v235, v218, v222
    s_add_u32 s7, s101, 294912
    buffer_store_dwordx4 v[232:235], v22, s[8:11], s7 offen sc1
    v_cvt_pk_bf16_f32 v237, v203, v207
    v_cvt_pk_bf16_f32 v239, v219, v223
    s_add_u32 s7, s101, 442368
    buffer_store_dwordx4 v[236:239], v22, s[8:11], s7 offen sc1
    v_cvt_pk_bf16_f32 v96, v64, v68
    v_cvt_pk_bf16_f32 v98, v80, v84
    v_cvt_pk_bf16_f32 v100, v65, v69
    v_cvt_pk_bf16_f32 v102, v81, v85
    v_cvt_pk_bf16_f32 v104, v66, v70
    v_cvt_pk_bf16_f32 v106, v82, v86
    v_cvt_pk_bf16_f32 v108, v67, v71
    v_cvt_pk_bf16_f32 v110, v83, v87
    v_cvt_pk_bf16_f32 v97, v72, v76
    v_cvt_pk_bf16_f32 v99, v88, v92
    s_add_u32 s7, s101, 4096
    buffer_store_dwordx4 v[96:99], v22, s[8:11], s7 offen sc1
    v_cvt_pk_bf16_f32 v101, v73, v77
    v_cvt_pk_bf16_f32 v103, v89, v93
    s_add_u32 s7, s101, 151552
    buffer_store_dwordx4 v[100:103], v22, s[8:11], s7 offen sc1
    v_cvt_pk_bf16_f32 v105, v74, v78
    v_cvt_pk_bf16_f32 v107, v90, v94
    s_add_u32 s7, s101, 299008
    buffer_store_dwordx4 v[104:107], v22, s[8:11], s7 offen sc1
    v_cvt_pk_bf16_f32 v109, v75, v79
    v_cvt_pk_bf16_f32 v111, v91, v95
    s_add_u32 s7, s101, 446464
    buffer_store_dwordx4 v[108:111], v22, s[8:11], s7 offen sc1
K_B_SIG:
    s_and_b32 s30, s5, 3
    v_mul_u32_u24 v7, 272, v4
    v_lshl_add_u32 v12, v3, 4, v7
    s_mul_i32 s7, s3, 2176
    v_add_u32 v12, s7, v12
    v_lshlrev_b32 v7, 15, v4
    v_lshl_add_u32 v13, v3, 4, v7
    v_xor_b32 v17, 98304, v13
    v_lshlrev_b32 v7, 5, v3
    v_sub_u32 v19, v12, v7
    v_add_u32 v19, 240, v19
    s_lshl_b32 s6, s96, 11
    s_lshl_b32 s7, s30, 8
    s_add_u32 s6, s6, s7
    s_lshl_b32 s7, s3, 18
    s_add_u32 s6, s6, s7
    s_add_u32 s34, s6, 1024
    s_sub_u32 s97, 4097792, s6
    v_add_u32 v23, 98304, v36
    v_mov_b32 v18, 0xffff
    s_and_b32 s33, s5, 4
    s_mul_i32 s33, s33, 18432
    s_cmp_ge_u32 s3, 4
    s_cbranch_scc1 K_B_AUX
    v_lshrrev_b32 v8, 1, v4
    v_and_b32 v9, 1, v4
    s_sub_u32 s6, 16, s31
    s_and_b32 s6, s6, 15
    s_lshl_b32 s7, s3, 2
    s_sub_u32 s28, 13, s7
    s_sub_u32 s35, 3, s30
    s_cmp_ge_u32 s3, 2
    s_cselect_b32 s6, s6, s31
    s_cselect_b32 s7, s28, s7
    s_cselect_b32 s35, s35, s30
    s_cselect_b32 s58, 0x80008000, 0
    s_cselect_b32 s28, 3, 0
    s_cselect_b32 s29, 7, 0
    s_mul_i32 s6, s6, 147456
    s_lshl_b32 s7, s7, 9
    s_add_u32 s6, s6, s7
    s_lshl_b32 s35, s35, 7
    s_add_u32 s35, s35, s6
    v_mul_u32_u24 v7, 4608, v4
    v_lshl_add_u32 v7, v6, 4, v7
    v_bfe_u32 v10, v2, 3, 1
    v_lshlrev_b32 v10, 1, v10
    v_xor_b32 v10, s28, v10
    v_xor_b32_e64 v11, 1, v10
    v_lshl_add_u32 v10, v10, 9, v7
    v_lshl_add_u32 v11, v11, 9, v7
    v_mul_u32_u24 v7, 272, v3
    v_lshl_add_u32 v7, v8, 2, v7
    s_lshl_b32 s6, s3, 3
    v_add_u32 v7, s6, v7
    v_lshlrev_b32 v9, 2, v9
    v_xor_b32 v9, s29, v9
    v_xor_b32 v8, 0, v9
    v_lshl_add_u32 v24, v8, 5, v7
    v_xor_b32 v8, 1, v9
    v_lshl_add_u32 v25, v8, 5, v7
    v_xor_b32 v8, 2, v9
    v_lshl_add_u32 v26, v8, 5, v7
    v_xor_b32 v8, 3, v9
    v_lshl_add_u32 v27, v8, 5, v7
    v_mov_b32 v20, v10
    v_mov_b32 v21, v11
    s_sub_u32 s100, s35, s33
    s_add_u32 s35, s35, s33
    s_cmp_lg_u32 s3, 2
    s_cbranch_scc1 K_B_RDY_X
    v_lshlrev_b32 v7, 2, v6
    s_mov_b32 s28, 0
K_B_RDY:
    buffer_load_dword v9, v7, s[16:19], 0 offen sc1
    s_add_u32 s28, s28, 1
    s_cmp_ge_u32 s28, 400000
    s_cbranch_scc1 K_B_RDY_X
    s_waitcnt vmcnt(0)
    v_cmp_ne_u32 vcc, 1, v9
    s_cmp_lg_u64 vcc, 0
    s_cbranch_scc1 K_B_RDY
K_B_RDY_X:
    s_waitcnt vmcnt(0)
    s_barrier
    s_cmp_lg_u32 s3, 3
    s_cbranch_scc1 K_B_NOSIG
    s_lshl_b32 s6, s4, 3
    s_add_u32 s6, s6, s5
    s_lshl_b32 s6, s6, 7
    s_add_u32 s6, s6, 49152
    s_mov_b64 exec, 1
    buffer_store_dword v15, v14, s[60:63], s6 offen sc1
    s_mov_b64 exec, -1
K_B_NOSIG:
    s_add_u32 s24, s56, 0x0
    s_addc_u32 s25, s57, 0
    s_mov_b32 s26, 0x240000
    s_mov_b32 s27, 0x20000
    s_lshl_b32 s6, s4, 3
    s_add_u32 s6, s6, s5
    s_lshl_b32 s6, s6, 3
    s_add_u32 s6, s6, s3
    s_mul_i32 s6, s6, 4608
    s_mov_b32 exec_hi, 15
    buffer_load_dword v31, v16, s[24:27], s6 offen sc1
    s_mov_b64 exec, -1
    ds_read_b128 v[32:35], v23 offset:0
    ds_read_b128 v[36:39], v23 offset:8192
    ds_read_b128 v[40:43], v23 offset:16384
    ds_read_b128 v[44:47], v23 offset:24576
    ds_read_b128 v[48:51], v23 offset:1024
    ds_read_b128 v[52:55], v23 offset:9216
    ds_read_b128 v[56:59], v23 offset:17408
    ds_read_b128 v[60:63], v23 offset:25600
    ds_read_b128 v[64:67], v23 offset:2048
    ds_read_b128 v[68:71], v23 offset:10240
    ds_read_b128 v[72:75], v23 offset:18432
    ds_read_b128 v[76:79], v23 offset:26624
    ds_read_b128 v[80:83], v23 offset:3072
    ds_read_b128 v[84:87], v23 offset:11264
    ds_read_b128 v[88:91], v23 offset:19456
    ds_read_b128 v[92:95], v23 offset:27648
    ds_read_b128 v[96:99], v23 offset:4096
    ds_read_b128 v[100:103], v23 offset:12288
    ds_read_b128 v[104:107], v23 offset:20480
    ds_read_b128 v[108:111], v23 offset:28672
    ds_read_b128 v[112:115], v23 offset:5120
    ds_read_b128 v[116:119], v23 offset:13312
    ds_read_b128 v[120:123], v23 offset:21504
    ds_read_b128 v[124:127], v23 offset:29696
    ds_read_b128 v[128:131], v23 offset:6144
    ds_read_b128 v[132:135], v23 offset:14336
    ds_read_b128 v[136:139], v23 offset:22528
    ds_read_b128 v[140:143], v23 offset:30720
    ds_read_b128 v[144:147], v23 offset:7168
    ds_read_b128 v[148:151], v23 offset:15360
    ds_read_b128 v[152:155], v23 offset:23552
    ds_read_b128 v[156:159], v23 offset:31744
    s_cmp_lg_u32 s3, 3
    s_cbranch_scc1 K_B_POLL_X
    s_mov_b32 s7, 49152
    s_mov_b32 s28, 0
K_B_POLL:
    buffer_load_dword v9, v16, s[60:63], s7 offen sc1
    s_add_u32 s28, s28, 1
    s_cmp_ge_u32 s28, 400000
    s_cbranch_scc1 K_B_POLL_X
    s_waitcnt vmcnt(0)
    v_cmp_ne_u32 vcc, 1, v9
    s_cmp_lg_u64 vcc, 0
    s_cbranch_scc1 K_B_POLL
K_B_POLL_X:
    s_barrier
    s_add_u32 s7, s35, 0
    buffer_load_dwordx4 v[160:163], v20, s[8:11], s7 offen sc1
    buffer_load_dwordx4 v[164:167], v21, s[8:11], s7 offen sc1
    s_add_u32 s7, s35, 18432
    buffer_load_dwordx4 v[168:171], v20, s[8:11], s7 offen sc1
    buffer_load_dwordx4 v[172:175], v21, s[8:11], s7 offen sc1
    s_add_u32 s7, s35, 36864
    buffer_load_dwordx4 v[176:179], v20, s[8:11], s7 offen sc1
    buffer_load_dwordx4 v[180:183], v21, s[8:11], s7 offen sc1
    s_add_u32 s7, s35, 55296
    buffer_load_dwordx4 v[184:187], v20, s[8:11], s7 offen sc1
    buffer_load_dwordx4 v[188:191], v21, s[8:11], s7 offen sc1
    s_add_u32 s7, s100, 73728
    buffer_load_dwordx4 v[192:195], v20, s[8:11], s7 offen sc1
    buffer_load_dwordx4 v[196:199], v21, s[8:11], s7 offen sc1
    s_add_u32 s7, s100, 92160
    buffer_load_dwordx4 v[200:203], v20, s[8:11], s7 offen sc1
    buffer_load_dwordx4 v[204:207], v21, s[8:11], s7 offen sc1
    s_add_u32 s7, s100, 110592
    buffer_load_dwordx4 v[208:211], v20, s[8:11], s7 offen sc1
    buffer_load_dwordx4 v[212:215], v21, s[8:11], s7 offen sc1
    s_add_u32 s7, s100, 129024
    buffer_load_dwordx4 v[216:219], v20, s[8:11], s7 offen sc1
    buffer_load_dwordx4 v[220:223], v21, s[8:11], s7 offen sc1
    s_waitcnt vmcnt(14) lgkmcnt(0)
    v_xor_b32 v162, s58, v162
    v_xor_b32 v163, s58, v163
    v_xor_b32 v166, s58, v166
    v_xor_b32_e64 v167, s58, v167
    v_mfma_f32_16x16x32_bf16 v[224:227], v[160:163], v[32:35], 0
    v_mfma_f32_16x16x32_bf16 v[232:235], v[160:163], v[36:39], 0
    v_mfma_f32_16x16x32_bf16 v[240:243], v[160:163], v[40:43], 0
    v_mfma_f32_16x16x32_bf16 v[248:251], v[160:163], v[44:47], 0
    v_mfma_f32_16x16x32_bf16 v[228:231], v[164:167], v[32:35], 0
    v_mfma_f32_16x16x32_bf16 v[236:239], v[164:167], v[36:39], 0
    v_mfma_f32_16x16x32_bf16 v[244:247], v[164:167], v[40:43], 0
    v_mfma_f32_16x16x32_bf16 v[252:255], v[164:167], v[44:47], 0
    s_waitcnt vmcnt(12) lgkmcnt(0)
    v_xor_b32 v170, s58, v170
    v_xor_b32 v171, s58, v171
    v_xor_b32 v174, s58, v174
    v_xor_b32_e64 v175, s58, v175
    v_mfma_f32_16x16x32_bf16 v[224:227], v[168:171], v[48:51], v[224:227]
    v_mfma_f32_16x16x32_bf16 v[232:235], v[168:171], v[52:55], v[232:235]
    v_mfma_f32_16x16x32_bf16 v[240:243], v[168:171], v[56:59], v[240:243]
    v_mfma_f32_16x16x32_bf16 v[248:251], v[168:171], v[60:63], v[248:251]
    v_mfma_f32_16x16x32_bf16 v[228:231], v[172:175], v[48:51], v[228:231]
    v_mfma_f32_16x16x32_bf16 v[236:239], v[172:175], v[52:55], v[236:239]
    v_mfma_f32_16x16x32_bf16 v[244:247], v[172:175], v[56:59], v[244:247]
    v_mfma_f32_16x16x32_bf16 v[252:255], v[172:175], v[60:63], v[252:255]
    s_waitcnt vmcnt(10) lgkmcnt(0)
    v_xor_b32 v178, s58, v178
    v_xor_b32 v179, s58, v179
    v_xor_b32 v182, s58, v182
    v_xor_b32_e64 v183, s58, v183
    v_mfma_f32_16x16x32_bf16 v[224:227], v[176:179], v[64:67], v[224:227]
    v_mfma_f32_16x16x32_bf16 v[232:235], v[176:179], v[68:71], v[232:235]
    v_mfma_f32_16x16x32_bf16 v[240:243], v[176:179], v[72:75], v[240:243]
    v_mfma_f32_16x16x32_bf16 v[248:251], v[176:179], v[76:79], v[248:251]
    v_mfma_f32_16x16x32_bf16 v[228:231], v[180:183], v[64:67], v[228:231]
    v_mfma_f32_16x16x32_bf16 v[236:239], v[180:183], v[68:71], v[236:239]
    v_mfma_f32_16x16x32_bf16 v[244:247], v[180:183], v[72:75], v[244:247]
    v_mfma_f32_16x16x32_bf16 v[252:255], v[180:183], v[76:79], v[252:255]
    s_waitcnt vmcnt(8) lgkmcnt(0)
    v_xor_b32 v186, s58, v186
    v_xor_b32 v187, s58, v187
    v_xor_b32 v190, s58, v190
    v_xor_b32_e64 v191, s58, v191
    v_mfma_f32_16x16x32_bf16 v[224:227], v[184:187], v[80:83], v[224:227]
    v_mfma_f32_16x16x32_bf16 v[232:235], v[184:187], v[84:87], v[232:235]
    v_mfma_f32_16x16x32_bf16 v[240:243], v[184:187], v[88:91], v[240:243]
    v_mfma_f32_16x16x32_bf16 v[248:251], v[184:187], v[92:95], v[248:251]
    v_mfma_f32_16x16x32_bf16 v[228:231], v[188:191], v[80:83], v[228:231]
    v_mfma_f32_16x16x32_bf16 v[236:239], v[188:191], v[84:87], v[236:239]
    v_mfma_f32_16x16x32_bf16 v[244:247], v[188:191], v[88:91], v[244:247]
    v_mfma_f32_16x16x32_bf16 v[252:255], v[188:191], v[92:95], v[252:255]
    s_waitcnt vmcnt(6) lgkmcnt(0)
    v_xor_b32 v194, s58, v194
    v_xor_b32 v195, s58, v195
    v_xor_b32 v198, s58, v198
    v_xor_b32_e64 v199, s58, v199
    v_mfma_f32_16x16x32_bf16 v[224:227], v[192:195], v[96:99], v[224:227]
    v_mfma_f32_16x16x32_bf16 v[232:235], v[192:195], v[100:103], v[232:235]
    v_mfma_f32_16x16x32_bf16 v[240:243], v[192:195], v[104:107], v[240:243]
    v_mfma_f32_16x16x32_bf16 v[248:251], v[192:195], v[108:111], v[248:251]
    v_mfma_f32_16x16x32_bf16 v[228:231], v[196:199], v[96:99], v[228:231]
    v_mfma_f32_16x16x32_bf16 v[236:239], v[196:199], v[100:103], v[236:239]
    v_mfma_f32_16x16x32_bf16 v[244:247], v[196:199], v[104:107], v[244:247]
    v_mfma_f32_16x16x32_bf16 v[252:255], v[196:199], v[108:111], v[252:255]
    s_waitcnt vmcnt(4) lgkmcnt(0)
    v_xor_b32 v202, s58, v202
    v_xor_b32 v203, s58, v203
    v_xor_b32 v206, s58, v206
    v_xor_b32_e64 v207, s58, v207
    v_mfma_f32_16x16x32_bf16 v[224:227], v[200:203], v[112:115], v[224:227]
    v_mfma_f32_16x16x32_bf16 v[232:235], v[200:203], v[116:119], v[232:235]
    v_mfma_f32_16x16x32_bf16 v[240:243], v[200:203], v[120:123], v[240:243]
    v_mfma_f32_16x16x32_bf16 v[248:251], v[200:203], v[124:127], v[248:251]
    v_mfma_f32_16x16x32_bf16 v[228:231], v[204:207], v[112:115], v[228:231]
    v_mfma_f32_16x16x32_bf16 v[236:239], v[204:207], v[116:119], v[236:239]
    v_mfma_f32_16x16x32_bf16 v[244:247], v[204:207], v[120:123], v[244:247]
    v_mfma_f32_16x16x32_bf16 v[252:255], v[204:207], v[124:127], v[252:255]
    s_waitcnt vmcnt(2) lgkmcnt(0)
    v_xor_b32 v210, s58, v210
    v_xor_b32 v211, s58, v211
    v_xor_b32 v214, s58, v214
    v_xor_b32_e64 v215, s58, v215
    v_mfma_f32_16x16x32_bf16 v[224:227], v[208:211], v[128:131], v[224:227]
    v_mfma_f32_16x16x32_bf16 v[232:235], v[208:211], v[132:135], v[232:235]
    v_mfma_f32_16x16x32_bf16 v[240:243], v[208:211], v[136:139], v[240:243]
    v_mfma_f32_16x16x32_bf16 v[248:251], v[208:211], v[140:143], v[248:251]
    v_mfma_f32_16x16x32_bf16 v[228:231], v[212:215], v[128:131], v[228:231]
    v_mfma_f32_16x16x32_bf16 v[236:239], v[212:215], v[132:135], v[236:239]
    v_mfma_f32_16x16x32_bf16 v[244:247], v[212:215], v[136:139], v[244:247]
    v_mfma_f32_16x16x32_bf16 v[252:255], v[212:215], v[140:143], v[252:255]
    s_waitcnt vmcnt(0) lgkmcnt(0)
    v_xor_b32 v218, s58, v218
    v_xor_b32 v219, s58, v219
    v_xor_b32 v222, s58, v222
    v_xor_b32_e64 v223, s58, v223
    v_mfma_f32_16x16x32_bf16 v[224:227], v[216:219], v[144:147], v[224:227]
    v_mfma_f32_16x16x32_bf16 v[232:235], v[216:219], v[148:151], v[232:235]
    v_mfma_f32_16x16x32_bf16 v[240:243], v[216:219], v[152:155], v[240:243]
    v_mfma_f32_16x16x32_bf16 v[248:251], v[216:219], v[156:159], v[248:251]
    v_mfma_f32_16x16x32_bf16 v[228:231], v[220:223], v[144:147], v[228:231]
    v_mfma_f32_16x16x32_bf16 v[236:239], v[220:223], v[148:151], v[236:239]
    v_mfma_f32_16x16x32_bf16 v[244:247], v[220:223], v[152:155], v[244:247]
    v_mfma_f32_16x16x32_bf16 v[252:255], v[220:223], v[156:159], v[252:255]
    s_cmp_lg_u32 s96, 0
    s_cbranch_scc1 K_B_NOX
    v_mov_b32 v64, 0xbf803f80
    v_mov_b32 v65, 0xbf803f80
    v_mov_b32 v66, 0
    v_mov_b32_e64 v67, 0
    s_nop 1
    v_mfma_f32_16x16x32_bf16 v[68:71], v[160:163], v[64:67], 0
    v_mfma_f32_16x16x32_bf16 v[72:75], v[164:167], v[64:67], 0
    v_mfma_f32_16x16x32_bf16 v[68:71], v[168:171], v[64:67], v[68:71]
    v_mfma_f32_16x16x32_bf16 v[72:75], v[172:175], v[64:67], v[72:75]
    v_mfma_f32_16x16x32_bf16 v[68:71], v[176:179], v[64:67], v[68:71]
    v_mfma_f32_16x16x32_bf16 v[72:75], v[180:183], v[64:67], v[72:75]
    v_mfma_f32_16x16x32_bf16 v[68:71], v[184:187], v[64:67], v[68:71]
    v_mfma_f32_16x16x32_bf16 v[72:75], v[188:191], v[64:67], v[72:75]
    v_mfma_f32_16x16x32_bf16 v[68:71], v[192:195], v[64:67], v[68:71]
    v_mfma_f32_16x16x32_bf16 v[72:75], v[196:199], v[64:67], v[72:75]
    v_mfma_f32_16x16x32_bf16 v[68:71], v[200:203], v[64:67], v[68:71]
    v_mfma_f32_16x16x32_bf16 v[72:75], v[204:207], v[64:67], v[72:75]
    v_mfma_f32_16x16x32_bf16 v[68:71], v[208:211], v[64:67], v[68:71]
    v_mfma_f32_16x16x32_bf16 v[72:75], v[212:215], v[64:67], v[72:75]
    v_mfma_f32_16x16x32_bf16 v[68:71], v[216:219], v[64:67], v[68:71]
    v_mfma_f32_16x16x32_bf16 v[72:75], v[220:223], v[64:67], v[72:75]
    s_nop 7
    v_cvt_pk_bf16_f32 v76, v68, v72
    ds_write_b32 v24, v76 offset:17408
    v_cvt_pk_bf16_f32 v77, v69, v73
    ds_write_b32 v25, v77 offset:17408
    v_cvt_pk_bf16_f32 v78, v70, v74
    ds_write_b32 v26, v78 offset:17408
    v_cvt_pk_bf16_f32 v79, v71, v75
    ds_write_b32 v27, v79 offset:17408
K_B_NOX:
    s_nop 2
    v_cvt_pk_bf16_f32 v32, v224, v228
    ds_write_b32 v24, v32 offset:0
    v_cvt_pk_bf16_f32 v33, v225, v229
    ds_write_b32 v25, v33 offset:0
    v_cvt_pk_bf16_f32 v34, v226, v230
    ds_write_b32 v26, v34 offset:0
    v_cvt_pk_bf16_f32 v35, v227, v231
    ds_write_b32 v27, v35 offset:0
    v_cvt_pk_bf16_f32 v36, v232, v236
    ds_write_b32 v24, v36 offset:4352
    v_cvt_pk_bf16_f32 v37, v233, v237
    ds_write_b32 v25, v37 offset:4352
    v_cvt_pk_bf16_f32 v38, v234, v238
    ds_write_b32 v26, v38 offset:4352
    v_cvt_pk_bf16_f32 v39, v235, v239
    ds_write_b32 v27, v39 offset:4352
    v_cvt_pk_bf16_f32 v40, v240, v244
    ds_write_b32 v24, v40 offset:8704
    v_cvt_pk_bf16_f32 v41, v241, v245
    ds_write_b32 v25, v41 offset:8704
    v_cvt_pk_bf16_f32 v42, v242, v246
    ds_write_b32 v26, v42 offset:8704
    v_cvt_pk_bf16_f32 v43, v243, v247
    ds_write_b32 v27, v43 offset:8704
    v_cvt_pk_bf16_f32 v44, v248, v252
    ds_write_b32 v24, v44 offset:13056
    v_cvt_pk_bf16_f32 v45, v249, v253
    ds_write_b32 v25, v45 offset:13056
    v_cvt_pk_bf16_f32 v46, v250, v254
    ds_write_b32 v26, v46 offset:13056
    v_cvt_pk_bf16_f32 v47, v251, v255
    ds_write_b32 v27, v47 offset:13056
    s_branch K_B_FIN
K_B_AUX:
    s_mov_b32 s7, 0
    s_mov_b32 s6, 0x43000000
K_B_GL2:
    v_mul_f32 v9, v240, v242
    v_cos_f32 v96, v9
    v_sin_f32 v100, v9
    v_add_f32 v9, v9, v240
    v_cos_f32 v97, v9
    v_sin_f32 v101, v9
    v_add_f32 v9, v9, v240
    v_cos_f32 v98, v9
    v_sin_f32 v102, v9
    v_add_f32 v9, v9, v240
    v_cos_f32 v99, v9
    v_sin_f32 v103, v9
    v_add_f32 v9, v9, v241
    v_cos_f32 v104, v9
    v_sin_f32 v108, v9
    v_add_f32 v9, v9, v240
    v_cos_f32 v105, v9
    v_sin_f32 v109, v9
    v_add_f32 v9, v9, v240
    v_cos_f32 v106, v9
    v_sin_f32 v110, v9
    v_add_f32 v9, v9, v240
    v_cos_f32 v107, v9
    v_sin_f32 v111, v9
    v_add_f32 v242, 0x42000000, v242
    v_cvt_pk_bf16_f32 v112, v96, v97
    v_cvt_pk_bf16_f32 v113, v98, v99
    v_cvt_pk_bf16_f32 v114, v100, v101
    v_cvt_pk_bf16_f32 v115, v102, v103
    ds_write_b128 v243, v[112:115] offset:0
    v_cvt_pk_bf16_f32 v116, v104, v105
    v_cvt_pk_bf16_f32 v117, v106, v107
    v_cvt_pk_bf16_f32 v118, v108, v109
    v_cvt_pk_bf16_f32 v119, v110, v111
    ds_write_b128 v243, v[116:119] offset:1024
    v_cmp_le_f32 vcc, s6, v242
    v_add_u32 v243, 2048, v243
    v_subrev_f32 v9, s6, v242
    s_add_u32 s7, s7, 1
    v_cndmask_b32 v242, v242, v9, vcc
    s_cmp_lt_u32 s7, 1
    s_cbranch_scc1 K_B_GL2
    s_sub_u32 s6, s3, 4
    s_lshl_b32 s7, s6, 13
    v_add_u32 v7, s7, v23
    s_mul_i32 s6, s6, 4352
    v_mul_u32_u24 v8, 272, v3
    v_add_u32 v8, s6, v8
    v_mul_u32_u24 v20, 4608, v4
    ds_read_b128 v[32:35], v7 offset:0
    ds_read_b128 v[36:39], v7 offset:1024
    ds_read_b128 v[40:43], v7 offset:2048
    ds_read_b128 v[44:47], v7 offset:3072
    ds_read_b128 v[48:51], v7 offset:4096
    ds_read_b128 v[52:55], v7 offset:5120
    ds_read_b128 v[56:59], v7 offset:6144
    ds_read_b128 v[60:63], v7 offset:7168
    s_add_u32 s6, s30, 1
    s_and_b32 s6, s6, 3
    s_lshl_b32 s6, s6, 7
    s_mul_i32 s7, s31, 147456
    s_add_u32 s6, s6, s7
    s_sub_u32 s100, s6, s33
    s_add_u32 s35, s6, s33
    s_setprio 3
    s_waitcnt vmcnt(0) lgkmcnt(0)
    s_barrier
    s_add_u32 s24, s56, 0x0
    s_addc_u32 s25, s57, 0
    s_mov_b32 s26, 0x240000
    s_mov_b32 s27, 0x20000
    s_lshl_b32 s6, s4, 3
    s_add_u32 s6, s6, s5
    s_lshl_b32 s6, s6, 3
    s_add_u32 s6, s6, s3
    s_mul_i32 s6, s6, 4608
    s_mov_b32 exec_hi, 15
    buffer_load_dword v31, v16, s[24:27], s6 offen sc1
    s_mov_b64 exec, -1
    s_barrier
    s_add_u32 s7, s35, 0
    buffer_load_dwordx4 v[160:163], v20, s[8:11], s7 offen sc1
    s_add_u32 s7, s35, 18432
    buffer_load_dwordx4 v[164:167], v20, s[8:11], s7 offen sc1
    s_add_u32 s7, s35, 36864
    buffer_load_dwordx4 v[168:171], v20, s[8:11], s7 offen sc1
    s_add_u32 s7, s35, 55296
    buffer_load_dwordx4 v[172:175], v20, s[8:11], s7 offen sc1
    s_add_u32 s7, s100, 73728
    buffer_load_dwordx4 v[176:179], v20, s[8:11], s7 offen sc1
    s_add_u32 s7, s100, 92160
    buffer_load_dwordx4 v[180:183], v20, s[8:11], s7 offen sc1
    s_add_u32 s7, s100, 110592
    buffer_load_dwordx4 v[184:187], v20, s[8:11], s7 offen sc1
    s_add_u32 s7, s100, 129024
    buffer_load_dwordx4 v[188:191], v20, s[8:11], s7 offen sc1
    s_waitcnt vmcnt(7) lgkmcnt(0)
    v_mfma_f32_16x16x32_bf16 v[224:227], v[160:163], v[32:35], 0
    s_waitcnt vmcnt(6) lgkmcnt(0)
    v_mfma_f32_16x16x32_bf16 v[224:227], v[164:167], v[36:39], v[224:227]
    s_waitcnt vmcnt(5) lgkmcnt(0)
    v_mfma_f32_16x16x32_bf16 v[224:227], v[168:171], v[40:43], v[224:227]
    s_waitcnt vmcnt(4) lgkmcnt(0)
    v_mfma_f32_16x16x32_bf16 v[224:227], v[172:175], v[44:47], v[224:227]
    s_waitcnt vmcnt(3) lgkmcnt(0)
    v_mfma_f32_16x16x32_bf16 v[224:227], v[176:179], v[48:51], v[224:227]
    s_waitcnt vmcnt(2) lgkmcnt(0)
    v_mfma_f32_16x16x32_bf16 v[224:227], v[180:183], v[52:55], v[224:227]
    s_waitcnt vmcnt(1) lgkmcnt(0)
    v_mfma_f32_16x16x32_bf16 v[224:227], v[184:187], v[56:59], v[224:227]
    s_waitcnt vmcnt(0) lgkmcnt(0)
    v_mfma_f32_16x16x32_bf16 v[224:227], v[188:191], v[60:63], v[224:227]
    s_nop 7
    v_cvt_pk_bf16_f32 v32, v224, v224
    ds_write_b16 v8, v32 offset:256
K_B_FIN:
    s_waitcnt lgkmcnt(0)
    s_barrier
    ds_read_b128 v[108:111], v12 offset:0
    ds_read_b128 v[112:115], v12 offset:1088
    ds_read_b128 v[80:83], v19 offset:0
    ds_read_b32 v84, v19 offset:16
    ds_read_b128 v[88:91], v19 offset:1088
    ds_read_b32 v92, v19 offset:1104
    s_add_u32 s6, s34, 0
    s_waitcnt lgkmcnt(5)
    buffer_store_dwordx4 v[108:111], v13, s[12:15], s6 offen sc1
    s_add_u32 s6, s34, 131072
    s_waitcnt lgkmcnt(4)
    buffer_store_dwordx4 v[112:115], v13, s[12:15], s6 offen sc1
    s_sub_u32 s7, s97, 0
    s_waitcnt lgkmcnt(2)
    v_bfi_b32 v96, v18, v84, v83
    v_bfi_b32 v97, v18, v83, v82
    v_bfi_b32 v98, v18, v82, v81
    v_bfi_b32 v99, v18, v81, v80
    buffer_store_dwordx4 v[96:99], v17, s[12:15], s7 offen sc1
    s_sub_u32 s7, s97, 131072
    s_waitcnt lgkmcnt(0)
    v_bfi_b32 v100, v18, v92, v91
    v_bfi_b32 v101, v18, v91, v90
    v_bfi_b32 v102, v18, v90, v89
    v_bfi_b32 v103, v18, v89, v88
    buffer_store_dwordx4 v[100:103], v17, s[12:15], s7 offen sc1
    s_or_b32 s6, s96, s3
    s_cmp_lg_u32 s6, 0
    s_cbranch_scc1 K_B_NOX2
    ds_read_b128 v[104:107], v12 offset:17408
    s_add_u32 s6, s34, 2097152
    s_mov_b64 exec, 0xffff
    s_waitcnt lgkmcnt(0)
    buffer_store_dwordx4 v[104:107], v13, s[12:15], s6 offen sc1
    s_mov_b64 exec, -1
K_B_NOX2:
    s_endpgm
K_END:
    s_endpgm
.fill 225, 4, 0xbf800000
K_PAD:
    s_endpgm
.section .rodata,"a"
.p2align 6
.amdhsa_kernel concat_heads__sliding_local_dilated__spectral_fnet__prompt_kernel
.amdhsa_next_free_vgpr 256
.amdhsa_next_free_sgpr 102
.amdhsa_accum_offset 256
.amdhsa_group_segment_fixed_size 0
.amdhsa_kernarg_size 88
.amdhsa_user_sgpr_count 2
.amdhsa_user_sgpr_kernarg_segment_ptr 1
.amdhsa_system_sgpr_workgroup_id_x 1
.end_amdhsa_kernel
```
